```python
import torch

def _softmax(x, axis=-1):
    return torch.softmax(x, dim=axis)
def _gelu(x):
    return torch.nn.functional.gelu(x, approximate="tanh")
def _silu(x):
    return torch.nn.functional.silu(x)
def _sigmoid(x):
    return torch.sigmoid(x)
def _layernorm(x, axis=-1, eps=1e-5):
    m = x.mean(dim=axis, keepdim=True)
    v = x.var(dim=axis, keepdim=True, unbiased=False)
    return (x - m) / torch.sqrt(v + eps)
def _scatter_add(tgt, idx, src, axis=0):
    return tgt.clone().index_add_(axis, idx, src)
def _segment_sum(src, seg, n):
    out = torch.zeros((n,) + src.shape[1:], dtype=src.dtype)
    return out.index_add_(0, seg, src)
def _pad(x, pw):
    flat = tuple(v for pair in reversed(pw) for v in pair)
    return torch.nn.functional.pad(x, flat)

kernel_name = 'recurrent_scan__sliding_local_dilated__swiglu_ffn__prompt'

def setup_inputs():

    _w = (lambda a: (lambda t: t.to(torch.bfloat16) if t.is_floating_point() else t)(torch.as_tensor(a)))
    def _A_setup():
        B, S, D = 1, 2048, 448
        return {
            "x": _w((lambda *s: torch.randn(*s, dtype=torch.bfloat16) * 0.05)(B, S, D)),
            "wqkv": _w((lambda *s: torch.randn(*s, dtype=torch.bfloat16) * 0.05)(D, 3 * D)),
            "wo": _w((lambda *s: torch.randn(*s, dtype=torch.bfloat16) * 0.05)(D, D)),
        }
    _A_in = _A_setup()

    def _B_setup():
        B, S, D, F = 1, 2048, 448, 1792
        return {
            "x": _w((lambda *s: torch.randn(*s, dtype=torch.bfloat16) * 0.05)(B, S, D)),
            "w_gate": _w((lambda *s: torch.randn(*s, dtype=torch.bfloat16) * 0.05)(D, F)),
            "w_up": _w((lambda *s: torch.randn(*s, dtype=torch.bfloat16) * 0.05)(D, F)),
            "w_down": _w((lambda *s: torch.randn(*s, dtype=torch.bfloat16) * 0.05)(F, D)),
        }
    _B_in = _B_setup()

    return {
        "A_x": _A_in["x"],
        "A_wqkv": _A_in["wqkv"],
        "A_wo": _A_in["wo"],
        "B_x": _B_in["x"],
        "B_w_gate": _B_in["w_gate"],
        "B_w_up": _B_in["w_up"],
        "B_w_down": _B_in["w_down"],
    }

def reference(A_x, A_wqkv, A_wo, B_x, B_w_gate, B_w_up, B_w_down):
    def _A_ref(x, wqkv, wo):
        B, S, D = x.shape
        H = 16; Dh = D // H
        W, dil = 8, 2
        qkv = (lambda x, *d: x.permute(*d))((x @ wqkv).reshape(B, S, 3, H, Dh), 2, 0, 3, 1, 4)
        q, k, v = qkv[0], qkv[1], qkv[2]
        scale = Dh ** -0.5
        pos = torch.arange(S)
        off = torch.arange(W) * dil
        idx = pos[:, None] - off[None, :]
        mask = idx >= 0
        idx_c = torch.where(mask, idx, 0).reshape(-1)
        kg = k[:, :, idx_c, :].reshape(B, H, S, W, Dh)
        vg = v[:, :, idx_c, :].reshape(B, H, S, W, Dh)
        logits = torch.einsum("bhsd,bhswd->bhsw", q, kg) * scale
        logits = torch.where(mask[None, None, :, :], logits, -1e9)
        attn = _softmax(logits, axis=-1)
        o = torch.einsum("bhsw,bhswd->bhsd", attn, vg)
        return (lambda x, *d: x.permute(*d))(o, 0, 2, 1, 3).reshape(B, S, D) @ wo

    def _B_ref(x, w_gate, w_up, w_down):
        g = _silu(x @ w_gate)
        u = x @ w_up
        return (g * u) @ w_down

    x = A_x
    xn = _layernorm(x, axis=-1)
    s = _A_ref(xn, A_wqkv, A_wo)
    g = _silu(_B_ref(xn, B_w_gate, B_w_up, B_w_down))
    return x + s * g
```

```asm
; @launch grid=(256,1,1) block=(512,1,1) lds=163840
.amdgcn_target "amdgcn-amd-amdhsa--gfx950"
.text
.globl recurrent_scan__sliding_local_dilated__swiglu_ffn__prompt_kernel
.p2align 8
.type recurrent_scan__sliding_local_dilated__swiglu_ffn__prompt_kernel,@function
recurrent_scan__sliding_local_dilated__swiglu_ffn__prompt_kernel:
  s_cmp_ge_u32 s2, 256
  s_cbranch_scc1 END
  s_load_dwordx16 s[16:31], s[0:1], 0
  s_load_dwordx4 s[32:35], s[0:1], 64
  s_memrealtime s[98:99]
  v_lshrrev_b32 v1, 6, v0
  v_and_b32 v0, 63, v0
  v_readfirstlane_b32 s57, v1
  s_getpc_b64 s[100:101]
  s_bfe_u32 s13, s2, 0x30003
  s_cmp_ge_u32 s57, 2
  s_cbranch_scc1 CW0
  s_mul_i32 s13, s13, s57
  s_lshl_b32 s13, s13, 13
  v_lshlrev_b32 v1, 7, v0
  v_add_u32 v1, s13, v1
  global_load_dword a47, v1, s[100:101]
CW0:
  s_and_b32 s3, s2, 7
  s_lshr_b32 s10, s2, 3
  s_and_b32 s4, s57, 3
  s_lshr_b32 s56, s57, 2
  s_and_b32 s11, s3, 3
  s_lshr_b32 s12, s3, 2
  s_lshl_b32 s12, s12, 3
  s_sub_u32 s13, s10, 4
  s_and_b32 s13, s13, 31
  s_mul_i32 s8, s13, 37
  s_lshr_b32 s8, s8, 8
  s_mul_i32 s9, s8, 7
  s_sub_u32 s9, s13, s9
  s_lshl_b32 s100, s3, 2
  s_add_u32 s8, s8, s100
  s_and_b32 s8, s8, 31
  s_and_b32 s100, s11, 1
  s_lshl_b32 s100, s100, 2
  s_and_b32 s101, s10, 3
  s_add_u32 s100, s100, s101
  s_lshr_b32 s6, s11, 1
  s_add_u32 s101, s6, 12
  s_cmp_lt_u32 s10, 4
  s_cselect_b32 s6, s6, s101
  s_sub_u32 s13, s10, 8
  s_and_b32 s13, s13, 31
  s_mul_i32 s101, s13, 11
  s_lshr_b32 s101, s101, 5
  s_mul_i32 s5, s101, 3
  s_sub_u32 s13, s13, s5
  s_mul_i32 s5, s11, 3
  s_add_u32 s13, s13, s5
  s_cmp_lt_u32 s10, 8
  s_cselect_b32 s6, s6, s13
  s_cselect_b32 s5, s100, s101
  s_and_b32 s5, s5, 7
  s_lshl_b32 s7, s6, 1
  s_add_u32 s7, s7, s5
  s_add_u32 s5, s5, s12
  s_mul_i32 s13, s7, 37
  s_lshr_b32 s13, s13, 8
  s_mul_i32 s13, s13, 7
  s_sub_u32 s7, s7, s13
  s_add_u32 s13, s7, 0
  s_sub_u32 s100, s13, 7
  s_cmp_ge_u32 s13, 7
  s_cselect_b32 s13, s100, s13
  s_lshl_b32 s72, s13, 7
  s_mul_i32 s79, s13, 172032
  s_mul_i32 s86, s13, 229376
  s_add_u32 s13, s7, 1
  s_sub_u32 s100, s13, 7
  s_cmp_ge_u32 s13, 7
  s_cselect_b32 s13, s100, s13
  s_lshl_b32 s73, s13, 7
  s_mul_i32 s80, s13, 172032
  s_mul_i32 s87, s13, 229376
  s_add_u32 s13, s7, 2
  s_sub_u32 s100, s13, 7
  s_cmp_ge_u32 s13, 7
  s_cselect_b32 s13, s100, s13
  s_lshl_b32 s74, s13, 7
  s_mul_i32 s81, s13, 172032
  s_mul_i32 s88, s13, 229376
  s_add_u32 s13, s7, 3
  s_sub_u32 s100, s13, 7
  s_cmp_ge_u32 s13, 7
  s_cselect_b32 s13, s100, s13
  s_lshl_b32 s75, s13, 7
  s_mul_i32 s82, s13, 172032
  s_mul_i32 s89, s13, 229376
  s_add_u32 s13, s7, 4
  s_sub_u32 s100, s13, 7
  s_cmp_ge_u32 s13, 7
  s_cselect_b32 s13, s100, s13
  s_lshl_b32 s76, s13, 7
  s_mul_i32 s83, s13, 172032
  s_mul_i32 s90, s13, 229376
  s_add_u32 s13, s7, 5
  s_sub_u32 s100, s13, 7
  s_cmp_ge_u32 s13, 7
  s_cselect_b32 s13, s100, s13
  s_lshl_b32 s77, s13, 7
  s_mul_i32 s84, s13, 172032
  s_mul_i32 s91, s13, 229376
  s_add_u32 s13, s7, 6
  s_sub_u32 s100, s13, 7
  s_cmp_ge_u32 s13, 7
  s_cselect_b32 s13, s100, s13
  s_lshl_b32 s78, s13, 7
  s_mul_i32 s85, s13, 172032
  s_mul_i32 s92, s13, 229376
  s_lshl_b32 s93, s57, 10
  s_lshl_b32 s94, s4, 12
  s_and_b32 s13, s4, 1
  s_mul_i32 s13, s13, 28672
  s_add_u32 s13, s13, 65536
  s_cmp_eq_u32 s56, 0
  s_cselect_b32 s58, s94, s13
  s_lshl_b32 s13, s56, 11
  s_add_u32 s94, s94, s13
  v_lshrrev_b32 v188, 3, v0
  v_and_b32 v189, 7, v0
  v_lshrrev_b32 v190, 4, v0
  v_xor_b32 v191, v189, v190
  v_xor_b32 v192, 4, v191
  s_lshl_b32 s13, s5, 7
  s_lshl_b32 s100, s4, 5
  s_add_u32 s13, s13, s100
  s_lshl_b32 s100, s56, 4
  s_add_u32 s13, s13, s100
  v_add_u32 v193, s13, v188
  v_mul_u32_u24 v193, 896, v193
  v_lshl_add_u32 v144, v191, 4, v193
  v_lshl_add_u32 v145, v192, 4, v193
  v_add_u32 v145, 6144, v145
  v_and_b32 v191, 1, v190
  v_lshlrev_b32 v191, 2, v191
  v_xor_b32 v191, v189, v191
  s_lshl_b32 s100, s57, 3
  v_add_u32 v193, s100, v188
  v_mul_u32_u24 v192, 2688, v193
  v_lshl_add_u32 v7, v191, 4, v192
  v_mul_u32_u24 v192, 3584, v193
  v_lshl_add_u32 v6, v191, 4, v192
  v_mul_u32_u24 v192, 896, v188
  v_lshl_add_u32 v196, v191, 4, v192
  v_add_u32 v197, 6144, v196
  v_add_u32 v198, 12288, v196
  v_add_u32 v199, 18432, v196
  s_lshl_b32 s13, s6, 7
  s_add_u32 s13, s13, 896
  s_mul_i32 s100, s6, 384
  s_cmp_lt_u32 s10, 4
  s_cselect_b32 s13, s100, s13
  s_waitcnt lgkmcnt(0)
  s_mov_b32 s36, s16
  s_mov_b32 s37, s17
  s_mov_b32 s38, 1835008
  s_mov_b32 s39, 0x00020000
  s_add_u32 s40, s18, s13
  s_addc_u32 s41, s19, 0
  s_sub_u32 s42, 1204224, s13
  s_mov_b32 s43, 0x00020000
  s_cmp_lt_u32 s10, 4
  s_cbranch_scc1 LIGHT
  s_add_u32 m0, s94, 65536
  s_nop 0
  buffer_load_dwordx4 v144, s[36:39], s72 offen offset:0 lds
  buffer_load_dwordx4 v145, s[36:39], s72 offen offset:1024 lds
  s_add_u32 m0, s93, 147456
  s_nop 0
  buffer_load_dwordx4 v7, s[40:43], s79 offen lds
  s_add_u32 m0, s94, 81920
  s_nop 0
  buffer_load_dwordx4 v144, s[36:39], s73 offen offset:0 lds
  buffer_load_dwordx4 v145, s[36:39], s73 offen offset:1024 lds
  s_add_u32 m0, s93, 155648
  s_nop 0
  buffer_load_dwordx4 v7, s[40:43], s80 offen lds
  s_mov_b32 s60, s34
  s_mov_b32 s61, s35
  s_mov_b32 s62, 16777216
  s_mov_b32 s63, 0x00020000
  s_mov_b32 s68, s32
  s_mov_b32 s69, s33
  s_mov_b32 s70, 256
  s_mov_b32 s71, 0x00020000
  s_or_b32 s100, s2, s57
  s_cmp_lg_u32 s100, 0
  s_cbranch_scc1 NONONCE1
  s_or_b32 s98, s98, 1
  v_mov_b32 v14, s98
  v_mov_b32 v15, s99
  s_mov_b64 exec, 1
  buffer_store_dwordx2 v[14:15], off, s[68:71], 0 sc1
  s_mov_b64 exec, -1
NONONCE1:
  s_lshl_b32 s14, s5, 12
  s_lshl_b32 s100, s4, 8
  s_add_u32 s14, s14, s100
  s_lshl_b32 s100, s6, 1
  s_add_u32 s100, s100, s56
  s_lshl_b32 s100, s100, 3
  s_add_u32 s14, s14, s100
  s_add_u32 s14, s14, 14680064
  s_lshl_b32 s100, s56, 1
  s_xor_b32 s100, s100, s4
  v_lshrrev_b32 v188, 5, v0
  v_bfe_u32 v189, v0, 2, 2
  v_bfe_u32 v191, v0, 3, 1
  v_lshlrev_b32 v191, 6, v191
  v_bfe_u32 v192, v0, 4, 1
  v_lshl_add_u32 v191, v192, 5, v191
  v_and_b32 v193, 3, v0
  v_lshl_add_u32 v191, v193, 3, v191
  v_lshl_add_u32 v190, v188, 3, v189
  v_lshl_add_u32 v1, v190, 7, v191
  s_lshl_b32 s13, s100, 11
  s_lshl_b32 s101, s56, 6
  s_add_u32 s13, s13, s101
  v_xor_b32 v1, s13, v1
  v_xor_b32 v2, 2048, v1
  v_xor_b32 v3, 4096, v1
  v_xor_b32 v4, 6144, v1
  v_lshl_add_u32 v190, v188, 2, v189
  v_lshl_add_u32 v200, v190, 7, v191
  v_add_u32 v200, s58, v200
  v_xor_b32 v201, 64, v200
  v_and_b32 v189, 31, v0
  v_bfe_u32 v190, v0, 1, 3
  v_xor_b32 v190, v190, v188
  v_lshlrev_b32 v190, 4, v190
  v_lshl_add_u32 v190, v189, 7, v190
  s_lshl_b32 s13, s100, 5
  s_lshl_b32 s101, s4, 12
  s_add_u32 s13, s13, s101
  v_xor_b32 v146, s13, v190
  v_xor_b32 v147, 32, v146
  v_xor_b32 v148, 64, v146
  v_xor_b32 v149, 96, v146
  s_lshl_b32 s13, s56, 9
  s_add_u32 s13, s13, 147456
  v_lshlrev_b32 v11, 4, v189
  v_add_u32 v11, s13, v11
  s_lshl_b32 s13, s4, 2
  v_add_u32 v12, s13, v11
  v_and_b32 v193, 15, v0
  v_lshrrev_b32 v194, 4, v0
  v_bfe_u32 v195, v0, 1, 3
  v_xor_b32 v195, v195, v194
  v_lshlrev_b32 v195, 4, v195
  v_lshl_add_u32 v195, v193, 7, v195
  v_add_u32 v150, s94, v195
  v_xor_b32 v151, 64, v150
  v_bfe_u32 v195, v0, 2, 2
  v_cmp_eq_u32 vcc, v195, v194
  s_lshr_b32 s13, s94, 7
  v_add_u32 v193, s13, v193
  v_add_u32 v194, 128, v0
  v_cndmask_b32 v204, v194, v193, vcc
  v_mov_b32 v160, 0x3f803f80
  v_mov_b32 v161, 0x3f803f80
  v_mov_b32 v162, 0x3f803f80
  v_mov_b32 v163, 0x3f803f80
  v_lshlrev_b32 v5, 4, v0
  v_and_b32 v189, 15, v0
  v_lshlrev_b32 v189, 4, v189
  v_lshl_add_u32 v189, v188, 8, v189
  v_lshl_add_u32 v202, v192, 10, v189
  v_bfe_u32 v189, v0, 2, 1
  v_cmp_eq_u32 vcc, v189, v192
  v_mov_b32 v190, 0x3f803f80
  v_mov_b32 v203, 0
  v_cndmask_b32 v176, 0, v190, vcc
  v_mov_b32 v177, v176
  v_mov_b32 v178, v176
  v_mov_b32 v179, v176
  v_mov_b32 v181, 0
  v_mov_b32 v183, 0
  s_add_u32 m0, s94, 98304
  s_nop 0
  buffer_load_dwordx4 v144, s[36:39], s74 offen offset:0 lds
  buffer_load_dwordx4 v145, s[36:39], s74 offen offset:1024 lds
  s_add_u32 m0, s93, 131072
  s_nop 0
  buffer_load_dwordx4 v7, s[40:43], s81 offen lds
  s_add_u32 m0, s94, 0
  s_nop 0
  buffer_load_dwordx4 v144, s[36:39], s75 offen offset:0 lds
  buffer_load_dwordx4 v145, s[36:39], s75 offen offset:1024 lds
  s_add_u32 m0, s93, 139264
  s_nop 0
  buffer_load_dwordx4 v7, s[40:43], s82 offen lds
  s_lshl_b32 s13, s6, 8
  s_and_b32 s100, s5, 1
  s_lshl_b32 s100, s100, 7
  s_add_u32 s13, s13, s100
  s_lshl_b32 s100, s100, 1
  s_sub_u32 s3, 128, s100
  s_add_u32 s44, s24, s13
  s_addc_u32 s45, s25, 0
  s_sub_u32 s46, 1605632, s13
  s_mov_b32 s47, 0x00020000
  s_add_u32 s48, s26, s13
  s_addc_u32 s49, s27, 0
  s_sub_u32 s50, 1605632, s13
  s_mov_b32 s51, 0x00020000
  s_lshl_b32 s13, s9, 7
  s_add_u32 s52, s28, s13
  s_addc_u32 s53, s29, 0
  s_sub_u32 s54, 1605632, s13
  s_mov_b32 s55, 0x00020000
  s_lshr_b32 s13, s4, 1
  s_and_b32 s100, s4, 1
  s_lshl_b32 s101, s13, 2
  s_add_u32 s101, s101, s100
  s_mul_i32 s95, s101, 28672
  s_add_u32 s96, s95, 57344
  s_bitcmp1_b32 s8, 1
  s_cselect_b32 s97, s96, s95
  s_cselect_b32 s96, s95, s96
  s_mov_b32 s95, s97
  s_mul_i32 s100, s100, 7
  s_mul_i32 s7, s4, 28672
  s_mul_i32 s97, s56, 14336
  s_add_u32 s7, s7, s97
  s_lshl_b32 s59, s8, 1
  s_add_u32 s97, s59, s13
  s_add_u32 s100, s100, 56
  s_cmp_eq_u32 s56, 0
  s_cselect_b32 s59, s59, s97
  s_cselect_b32 s101, s101, s100
  s_mul_i32 s59, s59, 143488
  s_lshl_b32 s101, s101, 11
  s_add_u32 s59, s59, s101
  s_mul_i32 s97, s56, 14336
  s_add_u32 s97, s97, s95
  s_lshl_b32 s13, s5, 2
  s_add_u32 s13, s13, s4
  s_lshl_b32 s101, s56, 11
  s_lshl_b32 s100, s6, 12
  s_add_u32 s100, s100, s101
  s_mul_i32 s10, s13, 57472
  s_add_u32 s10, s10, s100
  s_add_u32 s10, s10, 10485760
  s_mul_i32 s11, s13, 143488
  s_lshl_b32 s100, s6, 13
  s_add_u32 s100, s100, s101
  s_add_u32 s11, s11, s100
  s_add_u32 s12, s11, 4096
  s_waitcnt vmcnt(9)
  s_barrier
  v_add_u32 v146, 65536, v146
  ds_read_b128 v[16:19], v146 offset:0
  v_add_u32 v147, 65536, v147
  ds_read_b128 v[20:23], v147 offset:0
  v_add_u32 v148, 65536, v148
  ds_read_b128 v[24:27], v148 offset:0
  v_add_u32 v149, 65536, v149
  ds_read_b128 v[28:31], v149 offset:0
  v_add_u32 v150, 65536, v150
  ds_read_b128 a[32:35], v150 offset:0
  v_add_u32 v151, 65536, v151
  ds_read_b128 a[36:39], v151 offset:0
  v_add_u32 v1, 131072, v1
  ds_read_b64_tr_b16 a[0:1], v1 offset:16384
  ds_read_b64_tr_b16 a[2:3], v1 offset:16896
  v_add_u32 v2, 131072, v2
  ds_read_b64_tr_b16 a[4:5], v2 offset:16384
  ds_read_b64_tr_b16 a[6:7], v2 offset:16896
  v_add_u32 v3, 131072, v3
  ds_read_b64_tr_b16 a[8:9], v3 offset:16384
  ds_read_b64_tr_b16 a[10:11], v3 offset:16896
  v_add_u32 v4, 131072, v4
  ds_read_b64_tr_b16 a[12:13], v4 offset:16384
  ds_read_b64_tr_b16 a[14:15], v4 offset:16896
  s_add_u32 m0, s94, 16384
  s_nop 0
  buffer_load_dwordx4 v144, s[36:39], s76 offen offset:0 lds
  buffer_load_dwordx4 v145, s[36:39], s76 offen offset:1024 lds
  s_add_u32 m0, s93, 114688
  s_nop 0
  buffer_load_dwordx4 v7, s[40:43], s83 offen lds
  s_cmp_ge_u32 s6, 7
  s_cbranch_scc1 VSTAGE
  s_waitcnt lgkmcnt(8)
  s_waitcnt vmcnt(9)
  s_barrier
  s_waitcnt lgkmcnt(4)
  v_mfma_f32_32x32x16_bf16 v[128:143], a[0:3], v[16:19], 0
  ds_read_b64_tr_b16 a[16:17], v1 offset:24576
  ds_read_b64_tr_b16 a[18:19], v1 offset:25088
  s_add_u32 m0, s94, 32768
  s_nop 0
  buffer_load_dwordx4 v144, s[36:39], s77 offen offset:0 lds
  v_mfma_f32_16x16x32_bf16 v[152:155], v[160:163], a[32:35], 0
  v_mfma_f32_16x16x32_bf16 v[156:159], a[32:35], a[32:35], 0
  v_mfma_f32_16x16x32_bf16 v[152:155], v[160:163], a[36:39], v[152:155]
  v_mfma_f32_16x16x32_bf16 v[156:159], a[36:39], a[36:39], v[156:159]
  ds_read_b128 v[32:35], v146 offset:16384
  ds_read_b128 v[36:39], v147 offset:16384
  ds_read_b128 v[40:43], v148 offset:16384
  ds_read_b128 v[44:47], v149 offset:16384
  ds_read_b128 a[32:35], v150 offset:16384
  ds_read_b128 a[36:39], v151 offset:16384
  v_mfma_f32_32x32x16_bf16 v[128:143], a[4:7], v[20:23], v[128:143]
  ds_read_b64_tr_b16 a[20:21], v2 offset:24576
  ds_read_b64_tr_b16 a[22:23], v2 offset:25088
  buffer_load_dwordx4 v145, s[36:39], s77 offen offset:1024 lds
  v_mfma_f32_16x16x32_bf16 v[184:187], v[176:179], a[0:3], 0
  s_waitcnt lgkmcnt(10)
  v_mfma_f32_32x32x16_bf16 v[128:143], a[8:11], v[24:27], v[128:143]
  ds_read_b64_tr_b16 a[24:25], v3 offset:24576
  ds_read_b64_tr_b16 a[26:27], v3 offset:25088
  s_add_u32 m0, s93, 122880
  s_nop 0
  buffer_load_dwordx4 v7, s[40:43], s84 offen lds
  v_mfma_f32_32x32x16_bf16 v[128:143], a[12:15], v[28:31], v[128:143]
  ds_read_b64_tr_b16 a[28:29], v4 offset:24576
  ds_read_b64_tr_b16 a[30:31], v4 offset:25088
  s_add_u32 m0, s94, 49152
  s_nop 0
  buffer_load_dwordx4 v144, s[36:39], s78 offen offset:0 lds
  s_waitcnt lgkmcnt(6)
  s_waitcnt vmcnt(10)
  s_barrier
  s_waitcnt lgkmcnt(4)
  v_mfma_f32_32x32x16_bf16 v[128:143], a[16:19], v[32:35], v[128:143]
  ds_read_b64_tr_b16 a[0:1], v1 offset:0
  ds_read_b64_tr_b16 a[2:3], v1 offset:512
  buffer_load_dwordx4 v145, s[36:39], s78 offen offset:1024 lds
  v_mfma_f32_16x16x32_bf16 v[152:155], v[160:163], a[32:35], v[152:155]
  v_mfma_f32_16x16x32_bf16 v[156:159], a[32:35], a[32:35], v[156:159]
  v_mfma_f32_16x16x32_bf16 v[152:155], v[160:163], a[36:39], v[152:155]
  v_mfma_f32_16x16x32_bf16 v[156:159], a[36:39], a[36:39], v[156:159]
  ds_read_b128 v[48:51], v146 offset:32768
  ds_read_b128 v[52:55], v147 offset:32768
  ds_read_b128 v[56:59], v148 offset:32768
  ds_read_b128 v[60:63], v149 offset:32768
  ds_read_b128 a[32:35], v150 offset:32768
  ds_read_b128 a[36:39], v151 offset:32768
  v_mfma_f32_32x32x16_bf16 v[128:143], a[20:23], v[36:39], v[128:143]
  ds_read_b64_tr_b16 a[4:5], v2 offset:0
  ds_read_b64_tr_b16 a[6:7], v2 offset:512
  s_add_u32 m0, s93, 81920
  s_nop 0
  buffer_load_dwordx4 v7, s[40:43], s85 offen lds
  v_mfma_f32_16x16x32_bf16 v[184:187], v[176:179], a[16:19], v[184:187]
  s_waitcnt lgkmcnt(10)
  v_mfma_f32_32x32x16_bf16 v[128:143], a[24:27], v[40:43], v[128:143]
  ds_read_b64_tr_b16 a[8:9], v3 offset:0
  ds_read_b64_tr_b16 a[10:11], v3 offset:512
  s_add_u32 m0, s93, 90112
  s_nop 0
  buffer_load_dwordx4 v6, s[44:47], s86 offen lds
  v_mfma_f32_32x32x16_bf16 v[128:143], a[28:31], v[44:47], v[128:143]
  ds_read_b64_tr_b16 a[12:13], v4 offset:0
  ds_read_b64_tr_b16 a[14:15], v4 offset:512
  s_add_u32 m0, s93, 65536
  s_nop 0
  buffer_load_dwordx4 v6, s[44:47], s87 offen lds
  s_waitcnt lgkmcnt(6)
  s_waitcnt vmcnt(11)
  s_barrier
  s_waitcnt lgkmcnt(4)
  v_mfma_f32_32x32x16_bf16 v[128:143], a[0:3], v[48:51], v[128:143]
  ds_read_b64_tr_b16 a[16:17], v1 offset:8192
  ds_read_b64_tr_b16 a[18:19], v1 offset:8704
  s_add_u32 m0, s93, 73728
  s_nop 0
  buffer_load_dwordx4 v6, s[44:47], s88 offen lds
  v_mfma_f32_16x16x32_bf16 v[152:155], v[160:163], a[32:35], v[152:155]
  v_mfma_f32_16x16x32_bf16 v[156:159], a[32:35], a[32:35], v[156:159]
  v_mfma_f32_16x16x32_bf16 v[152:155], v[160:163], a[36:39], v[152:155]
  v_mfma_f32_16x16x32_bf16 v[156:159], a[36:39], a[36:39], v[156:159]
  v_add_u32 v146, 4294901760, v146
  ds_read_b128 v[64:67], v146 offset:0
  v_add_u32 v147, 4294901760, v147
  ds_read_b128 v[68:71], v147 offset:0
  v_add_u32 v148, 4294901760, v148
  ds_read_b128 v[72:75], v148 offset:0
  v_add_u32 v149, 4294901760, v149
  ds_read_b128 v[76:79], v149 offset:0
  v_add_u32 v150, 4294901760, v150
  ds_read_b128 a[32:35], v150 offset:0
  v_add_u32 v151, 4294901760, v151
  ds_read_b128 a[36:39], v151 offset:0
  v_mfma_f32_32x32x16_bf16 v[128:143], a[4:7], v[52:55], v[128:143]
  ds_read_b64_tr_b16 a[20:21], v2 offset:8192
  ds_read_b64_tr_b16 a[22:23], v2 offset:8704
  s_add_u32 m0, s93, 98304
  s_nop 0
  buffer_load_dwordx4 v6, s[44:47], s89 offen lds
  v_mfma_f32_16x16x32_bf16 v[184:187], v[176:179], a[0:3], v[184:187]
  s_waitcnt lgkmcnt(10)
  v_mfma_f32_32x32x16_bf16 v[128:143], a[8:11], v[56:59], v[128:143]
  ds_read_b64_tr_b16 a[24:25], v3 offset:8192
  ds_read_b64_tr_b16 a[26:27], v3 offset:8704
  s_add_u32 m0, s93, 106496
  s_nop 0
  buffer_load_dwordx4 v6, s[44:47], s90 offen lds
  v_mfma_f32_32x32x16_bf16 v[128:143], a[12:15], v[60:63], v[128:143]
  ds_read_b64_tr_b16 a[28:29], v4 offset:8192
  ds_read_b64_tr_b16 a[30:31], v4 offset:8704
  s_waitcnt lgkmcnt(6)
  s_waitcnt vmcnt(11)
  s_barrier
  s_waitcnt lgkmcnt(4)
  v_mfma_f32_32x32x16_bf16 v[128:143], a[16:19], v[64:67], v[128:143]
  v_add_u32 v1, 4294901760, v1
  ds_read_b64_tr_b16 a[0:1], v1 offset:49152
  ds_read_b64_tr_b16 a[2:3], v1 offset:49664
  s_add_u32 m0, s93, 0
  s_nop 0
  buffer_load_dwordx4 v6, s[44:47], s91 offen lds
  v_mfma_f32_16x16x32_bf16 v[152:155], v[160:163], a[32:35], v[152:155]
  v_mfma_f32_16x16x32_bf16 v[156:159], a[32:35], a[32:35], v[156:159]
  v_mfma_f32_16x16x32_bf16 v[152:155], v[160:163], a[36:39], v[152:155]
  v_mfma_f32_16x16x32_bf16 v[156:159], a[36:39], a[36:39], v[156:159]
  ds_read_b128 v[80:83], v146 offset:16384
  ds_read_b128 v[84:87], v147 offset:16384
  ds_read_b128 v[88:91], v148 offset:16384
  ds_read_b128 v[92:95], v149 offset:16384
  ds_read_b128 a[32:35], v150 offset:16384
  ds_read_b128 a[36:39], v151 offset:16384
  v_mfma_f32_32x32x16_bf16 v[128:143], a[20:23], v[68:71], v[128:143]
  v_add_u32 v2, 4294901760, v2
  ds_read_b64_tr_b16 a[4:5], v2 offset:49152
  ds_read_b64_tr_b16 a[6:7], v2 offset:49664
  s_add_u32 m0, s93, 8192
  s_nop 0
  buffer_load_dwordx4 v6, s[44:47], s92 offen lds
  v_mfma_f32_16x16x32_bf16 v[184:187], v[176:179], a[16:19], v[184:187]
  s_waitcnt lgkmcnt(10)
  v_mfma_f32_32x32x16_bf16 v[128:143], a[24:27], v[72:75], v[128:143]
  v_add_u32 v3, 4294901760, v3
  ds_read_b64_tr_b16 a[8:9], v3 offset:49152
  ds_read_b64_tr_b16 a[10:11], v3 offset:49664
  v_mfma_f32_32x32x16_bf16 v[128:143], a[28:31], v[76:79], v[128:143]
  v_add_u32 v4, 4294901760, v4
  ds_read_b64_tr_b16 a[12:13], v4 offset:49152
  ds_read_b64_tr_b16 a[14:15], v4 offset:49664
  s_waitcnt lgkmcnt(6)
  s_waitcnt vmcnt(10)
  s_barrier
  s_waitcnt lgkmcnt(4)
  v_mfma_f32_32x32x16_bf16 v[128:143], a[0:3], v[80:83], v[128:143]
  ds_read_b64_tr_b16 a[16:17], v1 offset:57344
  ds_read_b64_tr_b16 a[18:19], v1 offset:57856
  s_add_u32 m0, s93, 131072
  s_nop 0
  buffer_load_dwordx4 v6, s[48:51], s86 offen lds
  v_mfma_f32_16x16x32_bf16 v[152:155], v[160:163], a[32:35], v[152:155]
  v_mfma_f32_16x16x32_bf16 v[156:159], a[32:35], a[32:35], v[156:159]
  v_mfma_f32_16x16x32_bf16 v[152:155], v[160:163], a[36:39], v[152:155]
  v_mfma_f32_16x16x32_bf16 v[156:159], a[36:39], a[36:39], v[156:159]
  ds_read_b128 v[96:99], v146 offset:32768
  ds_read_b128 v[100:103], v147 offset:32768
  ds_read_b128 v[104:107], v148 offset:32768
  ds_read_b128 v[108:111], v149 offset:32768
  ds_read_b128 a[32:35], v150 offset:32768
  ds_read_b128 a[36:39], v151 offset:32768
  buffer_load_dwordx2 v[14:15], v203, s[68:71], 0 offen offset:0 sc1
  v_mfma_f32_32x32x16_bf16 v[128:143], a[4:7], v[84:87], v[128:143]
  ds_read_b64_tr_b16 a[20:21], v2 offset:57344
  ds_read_b64_tr_b16 a[22:23], v2 offset:57856
  s_add_u32 m0, s93, 139264
  s_nop 0
  buffer_load_dwordx4 v6, s[48:51], s87 offen lds
  v_mfma_f32_16x16x32_bf16 v[184:187], v[176:179], a[0:3], v[184:187]
  s_waitcnt lgkmcnt(10)
  v_mfma_f32_32x32x16_bf16 v[128:143], a[8:11], v[88:91], v[128:143]
  ds_read_b64_tr_b16 a[24:25], v3 offset:57344
  ds_read_b64_tr_b16 a[26:27], v3 offset:57856
  s_add_u32 m0, s93, 16384
  s_nop 0
  buffer_load_dwordx4 v6, s[48:51], s88 offen lds
  v_mfma_f32_32x32x16_bf16 v[128:143], a[12:15], v[92:95], v[128:143]
  ds_read_b64_tr_b16 a[28:29], v4 offset:57344
  ds_read_b64_tr_b16 a[30:31], v4 offset:57856
  s_add_u32 m0, s93, 24576
  s_nop 0
  buffer_load_dwordx4 v6, s[48:51], s89 offen lds
  s_waitcnt lgkmcnt(6)
  s_waitcnt vmcnt(12)
  s_barrier
  s_waitcnt lgkmcnt(4)
  v_mfma_f32_32x32x16_bf16 v[128:143], a[16:19], v[96:99], v[128:143]
  ds_read_b64_tr_b16 a[0:1], v1 offset:16384
  ds_read_b64_tr_b16 a[2:3], v1 offset:16896
  s_add_u32 m0, s93, 32768
  s_nop 0
  buffer_load_dwordx4 v6, s[48:51], s90 offen lds
  v_mfma_f32_16x16x32_bf16 v[152:155], v[160:163], a[32:35], v[152:155]
  v_mfma_f32_16x16x32_bf16 v[156:159], a[32:35], a[32:35], v[156:159]
  v_mfma_f32_16x16x32_bf16 v[152:155], v[160:163], a[36:39], v[152:155]
  v_mfma_f32_16x16x32_bf16 v[156:159], a[36:39], a[36:39], v[156:159]
  ds_read_b128 v[112:115], v146 offset:49152
  ds_read_b128 v[116:119], v147 offset:49152
  ds_read_b128 v[120:123], v148 offset:49152
  ds_read_b128 v[124:127], v149 offset:49152
  ds_read_b128 a[32:35], v150 offset:49152
  ds_read_b128 a[36:39], v151 offset:49152
  v_mfma_f32_32x32x16_bf16 v[128:143], a[20:23], v[100:103], v[128:143]
  ds_read_b64_tr_b16 a[4:5], v2 offset:16384
  ds_read_b64_tr_b16 a[6:7], v2 offset:16896
  s_add_u32 m0, s93, 40960
  s_nop 0
  buffer_load_dwordx4 v6, s[48:51], s91 offen lds
  v_mfma_f32_16x16x32_bf16 v[184:187], v[176:179], a[16:19], v[184:187]
  s_waitcnt lgkmcnt(10)
  v_mfma_f32_32x32x16_bf16 v[128:143], a[24:27], v[104:107], v[128:143]
  ds_read_b64_tr_b16 a[8:9], v3 offset:16384
  ds_read_b64_tr_b16 a[10:11], v3 offset:16896
  s_waitcnt lgkmcnt(4)
  v_mfma_f32_16x16x32_bf16 v[152:155], v[160:163], a[32:35], v[152:155]
  v_mfma_f32_16x16x32_bf16 v[156:159], a[32:35], a[32:35], v[156:159]
  v_mfma_f32_16x16x32_bf16 v[152:155], v[160:163], a[36:39], v[152:155]
  v_mfma_f32_16x16x32_bf16 v[156:159], a[36:39], a[36:39], v[156:159]
  v_mfma_f32_32x32x16_bf16 v[128:143], a[28:31], v[108:111], v[128:143]
  ds_read_b64_tr_b16 a[12:13], v4 offset:16384
  ds_read_b64_tr_b16 a[14:15], v4 offset:16896
  v_and_b32 v205, 3, v0
  v_cmp_eq_u32 vcc, 1, v205
  s_nop 1
  v_mul_f32 v152, 0xbb124925, v152
  v_lshlrev_b32 v206, 3, v204
  v_cndmask_b32 v153, v156, v157, vcc
  v_cmp_eq_u32 vcc, 2, v205
  v_add_u32 v206, 149504, v206
  v_lshlrev_b32 v207, 2, v204
  v_cndmask_b32 v153, v153, v158, vcc
  v_cmp_eq_u32 vcc, 3, v205
  v_add_u32 v207, 148480, v207
  v_mul_f32 v205, v152, v152
  v_cndmask_b32 v153, v153, v159, vcc
  v_cvt_pk_bf16_f32 v152, v152, v152
  v_mul_f32 v153, 0x3b124925, v153
  v_sub_f32 v153, v153, v205
  v_max_f32 v153, 0, v153
  v_cvt_pk_bf16_f32 v153, v153, v153
  v_and_b32 v153, 0xffff0000, v153
  v_add_f32 v153, 0x3727c5ac, v153
  v_cvt_pk_bf16_f32 v153, v153, v153
  v_and_b32 v153, 0xffff0000, v153
  v_sqrt_f32 v153, v153
  s_nop 0
  v_cvt_pk_bf16_f32 v153, v153, v153
  v_and_b32 v153, 0xffff0000, v153
  v_rcp_f32 v205, v153
  ds_write_b64 v206, v[152:153]
  ds_write_b32 v207, v205
  v_and_b32 v204, 31, v0
  s_lshl_b32 s13, s4, 8
  s_add_u32 s13, s13, 149504
  v_lshlrev_b32 v204, 3, v204
  v_add_u32 v204, s13, v204
  ds_write_b32 v12, v184
  s_waitcnt lgkmcnt(0)
  s_waitcnt vmcnt(13)
  s_barrier
  ds_read_b64 v[154:155], v204
  ds_read_b128 v[188:191], v11
  v_mfma_f32_32x32x16_bf16 v[128:143], a[0:3], v[112:115], v[128:143]
  ds_read_b64_tr_b16 a[16:17], v1 offset:24576
  ds_read_b64_tr_b16 a[18:19], v1 offset:25088
  s_add_u32 m0, s93, 114688
  s_nop 0
  buffer_load_dwordx4 v6, s[48:51], s92 offen lds
  v_mfma_f32_16x16x32_bf16 v[184:187], v[176:179], a[0:3], 0
  v_mfma_f32_32x32x16_bf16 v[128:143], a[4:7], v[116:119], v[128:143]
  ds_read_b64_tr_b16 a[20:21], v2 offset:24576
  ds_read_b64_tr_b16 a[22:23], v2 offset:25088
  s_add_u32 m0, s93, 122880
  s_ashr_i32 s15, s3, 31
  s_add_u32 s44, s44, s3
  s_addc_u32 s45, s45, s15
  s_sub_u32 s46, s46, s3
  buffer_load_dwordx4 v6, s[44:47], s86 offen lds
  v_mfma_f32_16x16x32_bf16 v[184:187], v[176:179], a[4:7], v[184:187]
  s_waitcnt lgkmcnt(5)
  v_cmp_gt_u32 vcc, 32, v0
  v_rcp_f32 v10, v155
  v_mul_f32 v9, v155, v155
  v_cndmask_b32 v180, 0, v154, vcc
  v_mul_f32 v8, 0xbfb8aa3b, v10
  v_mfma_f32_32x32x16_bf16 v[128:143], a[8:11], v[120:123], v[128:143]
  ds_read_b64_tr_b16 a[24:25], v3 offset:24576
  ds_read_b64_tr_b16 a[26:27], v3 offset:25088
  s_add_u32 m0, s93, 49152
  s_nop 0
  buffer_load_dwordx4 v6, s[44:47], s87 offen lds
  v_mfma_f32_16x16x32_bf16 v[184:187], v[176:179], a[8:11], v[184:187]
  v_mfma_f32_32x32x16_bf16 v[128:143], a[12:15], v[124:127], v[128:143]
  ds_read_b64_tr_b16 a[28:29], v4 offset:24576
  ds_read_b64_tr_b16 a[30:31], v4 offset:25088
  s_add_u32 m0, s93, 57344
  s_nop 0
  buffer_load_dwordx4 v6, s[44:47], s88 offen lds
  v_mfma_f32_16x16x32_bf16 v[184:187], v[176:179], a[12:15], v[184:187]
  s_lshl_b32 s13, s4, 7
  s_add_u32 s13, s13, 148480
  v_lshrrev_b32 v206, 5, v0
  v_lshlrev_b32 v206, 4, v206
  v_add_u32 v206, s13, v206
  ds_read_b32 v207, v206
  ds_read_b32 v207, v206
  ds_read_b32 v207, v206
  ds_read_b32 v207, v206
  v_mov_b32 v160, v10
  v_mov_b32 v161, v10
  v_mov_b32 v162, v10
  v_mov_b32 v163, v10
  v_mov_b32 v164, v10
  v_mov_b32 v165, v10
  v_mov_b32 v166, v10
  v_mov_b32 v167, v10
  v_mov_b32 v168, v10
  v_mov_b32 v169, v10
  v_mov_b32 v170, v10
  v_mov_b32 v171, v10
  v_mov_b32 v172, v10
  v_mov_b32 v173, v10
  v_mov_b32 v174, v10
  v_mov_b32 v175, v10
  s_branch KVDONE
VSTAGE:
  s_nop 11
  s_waitcnt lgkmcnt(8)
  s_waitcnt vmcnt(9)
  s_barrier
  s_waitcnt lgkmcnt(4)
  v_mfma_f32_32x32x16_bf16 v[128:143], v[16:19], a[0:3], 0
  ds_read_b64_tr_b16 a[16:17], v1 offset:24576
  ds_read_b64_tr_b16 a[18:19], v1 offset:25088
  s_add_u32 m0, s94, 32768
  s_nop 0
  buffer_load_dwordx4 v144, s[36:39], s77 offen offset:0 lds
  v_mfma_f32_16x16x32_bf16 v[152:155], v[160:163], a[32:35], 0
  v_mfma_f32_16x16x32_bf16 v[156:159], a[32:35], a[32:35], 0
  v_mfma_f32_16x16x32_bf16 v[152:155], v[160:163], a[36:39], v[152:155]
  v_mfma_f32_16x16x32_bf16 v[156:159], a[36:39], a[36:39], v[156:159]
  ds_read_b128 v[32:35], v146 offset:16384
  ds_read_b128 v[36:39], v147 offset:16384
  ds_read_b128 v[40:43], v148 offset:16384
  ds_read_b128 v[44:47], v149 offset:16384
  ds_read_b128 a[32:35], v150 offset:16384
  ds_read_b128 a[36:39], v151 offset:16384
  v_mfma_f32_32x32x16_bf16 v[128:143], v[20:23], a[4:7], v[128:143]
  ds_read_b64_tr_b16 a[20:21], v2 offset:24576
  ds_read_b64_tr_b16 a[22:23], v2 offset:25088
  buffer_load_dwordx4 v145, s[36:39], s77 offen offset:1024 lds
  v_mfma_f32_16x16x32_bf16 v[184:187], v[176:179], a[0:3], 0
  s_waitcnt lgkmcnt(10)
  v_mfma_f32_32x32x16_bf16 v[128:143], v[24:27], a[8:11], v[128:143]
  ds_read_b64_tr_b16 a[24:25], v3 offset:24576
  ds_read_b64_tr_b16 a[26:27], v3 offset:25088
  s_add_u32 m0, s93, 122880
  s_nop 0
  buffer_load_dwordx4 v7, s[40:43], s84 offen lds
  v_mfma_f32_32x32x16_bf16 v[128:143], v[28:31], a[12:15], v[128:143]
  ds_read_b64_tr_b16 a[28:29], v4 offset:24576
  ds_read_b64_tr_b16 a[30:31], v4 offset:25088
  s_add_u32 m0, s94, 49152
  s_nop 0
  buffer_load_dwordx4 v144, s[36:39], s78 offen offset:0 lds
  s_waitcnt lgkmcnt(6)
  s_waitcnt vmcnt(10)
  s_barrier
  s_waitcnt lgkmcnt(4)
  v_mfma_f32_32x32x16_bf16 v[128:143], v[32:35], a[16:19], v[128:143]
  ds_read_b64_tr_b16 a[0:1], v1 offset:0
  ds_read_b64_tr_b16 a[2:3], v1 offset:512
  buffer_load_dwordx4 v145, s[36:39], s78 offen offset:1024 lds
  v_mfma_f32_16x16x32_bf16 v[152:155], v[160:163], a[32:35], v[152:155]
  v_mfma_f32_16x16x32_bf16 v[156:159], a[32:35], a[32:35], v[156:159]
  v_mfma_f32_16x16x32_bf16 v[152:155], v[160:163], a[36:39], v[152:155]
  v_mfma_f32_16x16x32_bf16 v[156:159], a[36:39], a[36:39], v[156:159]
  ds_read_b128 v[48:51], v146 offset:32768
  ds_read_b128 v[52:55], v147 offset:32768
  ds_read_b128 v[56:59], v148 offset:32768
  ds_read_b128 v[60:63], v149 offset:32768
  ds_read_b128 a[32:35], v150 offset:32768
  ds_read_b128 a[36:39], v151 offset:32768
  v_mfma_f32_32x32x16_bf16 v[128:143], v[36:39], a[20:23], v[128:143]
  ds_read_b64_tr_b16 a[4:5], v2 offset:0
  ds_read_b64_tr_b16 a[6:7], v2 offset:512
  s_add_u32 m0, s93, 81920
  s_nop 0
  buffer_load_dwordx4 v7, s[40:43], s85 offen lds
  v_mfma_f32_16x16x32_bf16 v[184:187], v[176:179], a[16:19], v[184:187]
  s_waitcnt lgkmcnt(10)
  v_mfma_f32_32x32x16_bf16 v[128:143], v[40:43], a[24:27], v[128:143]
  ds_read_b64_tr_b16 a[8:9], v3 offset:0
  ds_read_b64_tr_b16 a[10:11], v3 offset:512
  s_add_u32 m0, s93, 90112
  s_nop 0
  buffer_load_dwordx4 v6, s[44:47], s86 offen lds
  v_mfma_f32_32x32x16_bf16 v[128:143], v[44:47], a[28:31], v[128:143]
  ds_read_b64_tr_b16 a[12:13], v4 offset:0
  ds_read_b64_tr_b16 a[14:15], v4 offset:512
  s_add_u32 m0, s93, 65536
  s_nop 0
  buffer_load_dwordx4 v6, s[44:47], s87 offen lds
  s_waitcnt lgkmcnt(6)
  s_waitcnt vmcnt(11)
  s_barrier
  s_waitcnt lgkmcnt(4)
  v_mfma_f32_32x32x16_bf16 v[128:143], v[48:51], a[0:3], v[128:143]
  ds_read_b64_tr_b16 a[16:17], v1 offset:8192
  ds_read_b64_tr_b16 a[18:19], v1 offset:8704
  s_add_u32 m0, s93, 73728
  s_nop 0
  buffer_load_dwordx4 v6, s[44:47], s88 offen lds
  v_mfma_f32_16x16x32_bf16 v[152:155], v[160:163], a[32:35], v[152:155]
  v_mfma_f32_16x16x32_bf16 v[156:159], a[32:35], a[32:35], v[156:159]
  v_mfma_f32_16x16x32_bf16 v[152:155], v[160:163], a[36:39], v[152:155]
  v_mfma_f32_16x16x32_bf16 v[156:159], a[36:39], a[36:39], v[156:159]
  v_add_u32 v146, 4294901760, v146
  ds_read_b128 v[64:67], v146 offset:0
  v_add_u32 v147, 4294901760, v147
  ds_read_b128 v[68:71], v147 offset:0
  v_add_u32 v148, 4294901760, v148
  ds_read_b128 v[72:75], v148 offset:0
  v_add_u32 v149, 4294901760, v149
  ds_read_b128 v[76:79], v149 offset:0
  v_add_u32 v150, 4294901760, v150
  ds_read_b128 a[32:35], v150 offset:0
  v_add_u32 v151, 4294901760, v151
  ds_read_b128 a[36:39], v151 offset:0
  v_mfma_f32_32x32x16_bf16 v[128:143], v[52:55], a[4:7], v[128:143]
  ds_read_b64_tr_b16 a[20:21], v2 offset:8192
  ds_read_b64_tr_b16 a[22:23], v2 offset:8704
  s_add_u32 m0, s93, 98304
  s_nop 0
  buffer_load_dwordx4 v6, s[44:47], s89 offen lds
  v_mfma_f32_16x16x32_bf16 v[184:187], v[176:179], a[0:3], v[184:187]
  s_waitcnt lgkmcnt(10)
  v_mfma_f32_32x32x16_bf16 v[128:143], v[56:59], a[8:11], v[128:143]
  ds_read_b64_tr_b16 a[24:25], v3 offset:8192
  ds_read_b64_tr_b16 a[26:27], v3 offset:8704
  s_add_u32 m0, s93, 106496
  s_nop 0
  buffer_load_dwordx4 v6, s[44:47], s90 offen lds
  v_mfma_f32_32x32x16_bf16 v[128:143], v[60:63], a[12:15], v[128:143]
  ds_read_b64_tr_b16 a[28:29], v4 offset:8192
  ds_read_b64_tr_b16 a[30:31], v4 offset:8704
  s_waitcnt lgkmcnt(6)
  s_waitcnt vmcnt(11)
  s_barrier
  s_waitcnt lgkmcnt(4)
  v_mfma_f32_32x32x16_bf16 v[128:143], v[64:67], a[16:19], v[128:143]
  v_add_u32 v1, 4294901760, v1
  ds_read_b64_tr_b16 a[0:1], v1 offset:49152
  ds_read_b64_tr_b16 a[2:3], v1 offset:49664
  s_add_u32 m0, s93, 0
  s_nop 0
  buffer_load_dwordx4 v6, s[44:47], s91 offen lds
  v_mfma_f32_16x16x32_bf16 v[152:155], v[160:163], a[32:35], v[152:155]
  v_mfma_f32_16x16x32_bf16 v[156:159], a[32:35], a[32:35], v[156:159]
  v_mfma_f32_16x16x32_bf16 v[152:155], v[160:163], a[36:39], v[152:155]
  v_mfma_f32_16x16x32_bf16 v[156:159], a[36:39], a[36:39], v[156:159]
  ds_read_b128 v[80:83], v146 offset:16384
  ds_read_b128 v[84:87], v147 offset:16384
  ds_read_b128 v[88:91], v148 offset:16384
  ds_read_b128 v[92:95], v149 offset:16384
  ds_read_b128 a[32:35], v150 offset:16384
  ds_read_b128 a[36:39], v151 offset:16384
  v_mfma_f32_32x32x16_bf16 v[128:143], v[68:71], a[20:23], v[128:143]
  v_add_u32 v2, 4294901760, v2
  ds_read_b64_tr_b16 a[4:5], v2 offset:49152
  ds_read_b64_tr_b16 a[6:7], v2 offset:49664
  s_add_u32 m0, s93, 8192
  s_nop 0
  buffer_load_dwordx4 v6, s[44:47], s92 offen lds
  v_mfma_f32_16x16x32_bf16 v[184:187], v[176:179], a[16:19], v[184:187]
  s_waitcnt lgkmcnt(10)
  v_mfma_f32_32x32x16_bf16 v[128:143], v[72:75], a[24:27], v[128:143]
  v_add_u32 v3, 4294901760, v3
  ds_read_b64_tr_b16 a[8:9], v3 offset:49152
  ds_read_b64_tr_b16 a[10:11], v3 offset:49664
  v_mfma_f32_32x32x16_bf16 v[128:143], v[76:79], a[28:31], v[128:143]
  v_add_u32 v4, 4294901760, v4
  ds_read_b64_tr_b16 a[12:13], v4 offset:49152
  ds_read_b64_tr_b16 a[14:15], v4 offset:49664
  s_waitcnt lgkmcnt(6)
  s_waitcnt vmcnt(10)
  s_barrier
  s_waitcnt lgkmcnt(4)
  v_mfma_f32_32x32x16_bf16 v[128:143], v[80:83], a[0:3], v[128:143]
  ds_read_b64_tr_b16 a[16:17], v1 offset:57344
  ds_read_b64_tr_b16 a[18:19], v1 offset:57856
  s_add_u32 m0, s93, 131072
  s_nop 0
  buffer_load_dwordx4 v6, s[48:51], s86 offen lds
  v_mfma_f32_16x16x32_bf16 v[152:155], v[160:163], a[32:35], v[152:155]
  v_mfma_f32_16x16x32_bf16 v[156:159], a[32:35], a[32:35], v[156:159]
  v_mfma_f32_16x16x32_bf16 v[152:155], v[160:163], a[36:39], v[152:155]
  v_mfma_f32_16x16x32_bf16 v[156:159], a[36:39], a[36:39], v[156:159]
  ds_read_b128 v[96:99], v146 offset:32768
  ds_read_b128 v[100:103], v147 offset:32768
  ds_read_b128 v[104:107], v148 offset:32768
  ds_read_b128 v[108:111], v149 offset:32768
  ds_read_b128 a[32:35], v150 offset:32768
  ds_read_b128 a[36:39], v151 offset:32768
  buffer_load_dwordx2 v[14:15], v203, s[68:71], 0 offen offset:0 sc1
  v_mfma_f32_32x32x16_bf16 v[128:143], v[84:87], a[4:7], v[128:143]
  ds_read_b64_tr_b16 a[20:21], v2 offset:57344
  ds_read_b64_tr_b16 a[22:23], v2 offset:57856
  s_add_u32 m0, s93, 139264
  s_nop 0
  buffer_load_dwordx4 v6, s[48:51], s87 offen lds
  v_mfma_f32_16x16x32_bf16 v[184:187], v[176:179], a[0:3], v[184:187]
  s_waitcnt lgkmcnt(10)
  v_mfma_f32_32x32x16_bf16 v[128:143], v[88:91], a[8:11], v[128:143]
  ds_read_b64_tr_b16 a[24:25], v3 offset:57344
  ds_read_b64_tr_b16 a[26:27], v3 offset:57856
  s_add_u32 m0, s93, 16384
  s_nop 0
  buffer_load_dwordx4 v6, s[48:51], s88 offen lds
  v_mfma_f32_32x32x16_bf16 v[128:143], v[92:95], a[12:15], v[128:143]
  ds_read_b64_tr_b16 a[28:29], v4 offset:57344
  ds_read_b64_tr_b16 a[30:31], v4 offset:57856
  s_add_u32 m0, s93, 24576
  s_nop 0
  buffer_load_dwordx4 v6, s[48:51], s89 offen lds
  s_waitcnt lgkmcnt(6)
  s_waitcnt vmcnt(12)
  s_barrier
  s_waitcnt lgkmcnt(4)
  v_mfma_f32_32x32x16_bf16 v[128:143], v[96:99], a[16:19], v[128:143]
  ds_read_b64_tr_b16 a[0:1], v1 offset:16384
  ds_read_b64_tr_b16 a[2:3], v1 offset:16896
  s_add_u32 m0, s93, 32768
  s_nop 0
  buffer_load_dwordx4 v6, s[48:51], s90 offen lds
  v_mfma_f32_16x16x32_bf16 v[152:155], v[160:163], a[32:35], v[152:155]
  v_mfma_f32_16x16x32_bf16 v[156:159], a[32:35], a[32:35], v[156:159]
  v_mfma_f32_16x16x32_bf16 v[152:155], v[160:163], a[36:39], v[152:155]
  v_mfma_f32_16x16x32_bf16 v[156:159], a[36:39], a[36:39], v[156:159]
  ds_read_b128 v[112:115], v146 offset:49152
  ds_read_b128 v[116:119], v147 offset:49152
  ds_read_b128 v[120:123], v148 offset:49152
  ds_read_b128 v[124:127], v149 offset:49152
  ds_read_b128 a[32:35], v150 offset:49152
  ds_read_b128 a[36:39], v151 offset:49152
  v_mfma_f32_32x32x16_bf16 v[128:143], v[100:103], a[20:23], v[128:143]
  ds_read_b64_tr_b16 a[4:5], v2 offset:16384
  ds_read_b64_tr_b16 a[6:7], v2 offset:16896
  s_add_u32 m0, s93, 40960
  s_nop 0
  buffer_load_dwordx4 v6, s[48:51], s91 offen lds
  v_mfma_f32_16x16x32_bf16 v[184:187], v[176:179], a[16:19], v[184:187]
  s_waitcnt lgkmcnt(10)
  v_mfma_f32_32x32x16_bf16 v[128:143], v[104:107], a[24:27], v[128:143]
  ds_read_b64_tr_b16 a[8:9], v3 offset:16384
  ds_read_b64_tr_b16 a[10:11], v3 offset:16896
  s_waitcnt lgkmcnt(4)
  v_mfma_f32_16x16x32_bf16 v[152:155], v[160:163], a[32:35], v[152:155]
  v_mfma_f32_16x16x32_bf16 v[156:159], a[32:35], a[32:35], v[156:159]
  v_mfma_f32_16x16x32_bf16 v[152:155], v[160:163], a[36:39], v[152:155]
  v_mfma_f32_16x16x32_bf16 v[156:159], a[36:39], a[36:39], v[156:159]
  v_mfma_f32_32x32x16_bf16 v[128:143], v[108:111], a[28:31], v[128:143]
  ds_read_b64_tr_b16 a[12:13], v4 offset:16384
  ds_read_b64_tr_b16 a[14:15], v4 offset:16896
  v_and_b32 v205, 3, v0
  v_cmp_eq_u32 vcc, 1, v205
  s_nop 1
  v_mul_f32 v152, 0xbb124925, v152
  v_lshlrev_b32 v206, 3, v204
  v_cndmask_b32 v153, v156, v157, vcc
  v_cmp_eq_u32 vcc, 2, v205
  v_add_u32 v206, 149504, v206
  v_lshlrev_b32 v207, 2, v204
  v_cndmask_b32 v153, v153, v158, vcc
  v_cmp_eq_u32 vcc, 3, v205
  v_add_u32 v207, 148480, v207
  v_mul_f32 v205, v152, v152
  v_cndmask_b32 v153, v153, v159, vcc
  v_cvt_pk_bf16_f32 v152, v152, v152
  v_mul_f32 v153, 0x3b124925, v153
  v_sub_f32 v153, v153, v205
  v_max_f32 v153, 0, v153
  v_cvt_pk_bf16_f32 v153, v153, v153
  v_and_b32 v153, 0xffff0000, v153
  v_add_f32 v153, 0x3727c5ac, v153
  v_cvt_pk_bf16_f32 v153, v153, v153
  v_and_b32 v153, 0xffff0000, v153
  v_sqrt_f32 v153, v153
  s_nop 0
  v_cvt_pk_bf16_f32 v153, v153, v153
  v_and_b32 v153, 0xffff0000, v153
  v_rcp_f32 v205, v153
  ds_write_b64 v206, v[152:153]
  ds_write_b32 v207, v205
  v_and_b32 v204, 31, v0
  s_lshl_b32 s13, s4, 8
  s_add_u32 s13, s13, 149504
  v_lshlrev_b32 v204, 3, v204
  v_add_u32 v204, s13, v204
  ds_write_b32 v12, v184
  s_waitcnt lgkmcnt(0)
  s_waitcnt vmcnt(13)
  s_barrier
  ds_read_b64 v[154:155], v204
  ds_read_b128 v[188:191], v11
  v_mfma_f32_32x32x16_bf16 v[128:143], v[112:115], a[0:3], v[128:143]
  ds_read_b64_tr_b16 a[16:17], v1 offset:24576
  ds_read_b64_tr_b16 a[18:19], v1 offset:25088
  s_add_u32 m0, s93, 114688
  s_nop 0
  buffer_load_dwordx4 v6, s[48:51], s92 offen lds
  v_mfma_f32_16x16x32_bf16 v[184:187], v[176:179], a[0:3], 0
  v_mfma_f32_32x32x16_bf16 v[128:143], v[116:119], a[4:7], v[128:143]
  ds_read_b64_tr_b16 a[20:21], v2 offset:24576
  ds_read_b64_tr_b16 a[22:23], v2 offset:25088
  s_add_u32 m0, s93, 122880
  s_ashr_i32 s15, s3, 31
  s_add_u32 s44, s44, s3
  s_addc_u32 s45, s45, s15
  s_sub_u32 s46, s46, s3
  buffer_load_dwordx4 v6, s[44:47], s86 offen lds
  v_mfma_f32_16x16x32_bf16 v[184:187], v[176:179], a[4:7], v[184:187]
  s_waitcnt lgkmcnt(5)
  v_cmp_gt_u32 vcc, 32, v0
  v_rcp_f32 v10, v155
  v_mul_f32 v9, v155, v155
  v_cndmask_b32 v180, 0, v154, vcc
  v_mul_f32 v8, 0xbfb8aa3b, v10
  v_mfma_f32_32x32x16_bf16 v[128:143], v[120:123], a[8:11], v[128:143]
  ds_read_b64_tr_b16 a[24:25], v3 offset:24576
  ds_read_b64_tr_b16 a[26:27], v3 offset:25088
  s_add_u32 m0, s93, 49152
  s_nop 0
  buffer_load_dwordx4 v6, s[44:47], s87 offen lds
  v_mfma_f32_16x16x32_bf16 v[184:187], v[176:179], a[8:11], v[184:187]
  v_mfma_f32_32x32x16_bf16 v[128:143], v[124:127], a[12:15], v[128:143]
  ds_read_b64_tr_b16 a[28:29], v4 offset:24576
  ds_read_b64_tr_b16 a[30:31], v4 offset:25088
  s_add_u32 m0, s93, 57344
  s_nop 0
  buffer_load_dwordx4 v6, s[44:47], s88 offen lds
  v_mfma_f32_16x16x32_bf16 v[184:187], v[176:179], a[12:15], v[184:187]
  s_lshl_b32 s13, s4, 7
  s_add_u32 s13, s13, 148480
  v_lshrrev_b32 v206, 5, v0
  v_lshlrev_b32 v206, 4, v206
  v_add_u32 v206, s13, v206
  ds_read_b128 v[160:163], v206 offset:0
  ds_read_b128 v[164:167], v206 offset:32
  ds_read_b128 v[168:171], v206 offset:64
  ds_read_b128 v[172:175], v206 offset:96
KVDONE:
  s_waitcnt vmcnt(16)
  s_barrier
  s_waitcnt lgkmcnt(8)
  v_mfma_f32_32x32x16_bf16 v[144:159], a[16:19], v[16:19], 0
  ds_read_b64_tr_b16 a[0:1], v1 offset:0
  ds_read_b64_tr_b16 a[2:3], v1 offset:512
  v_add_f32 v188, v188, v189
  v_add_f32 v190, v190, v191
  v_add_f32 v188, v188, v184
  v_add_f32 v188, v188, v190
  v_and_b32 v189, 0xffff0000, v188
  v_sub_f32 v188, v188, v189
  v_cvt_pk_bf16_f32 v182, v189, v188
  s_cmp_ge_u32 s6, 7
  s_cbranch_scc1 CV2
  v_mfma_f32_32x32x8_bf16 v[128:143], v[182:183], v[180:181], v[128:143]
  s_branch CD2
CV2:
  v_mfma_f32_32x32x8_bf16 v[128:143], v[180:181], v[182:183], v[128:143]
CD2:
  s_waitcnt lgkmcnt(2)
  v_mfma_f32_32x32x16_bf16 v[144:159], a[20:23], v[20:23], v[144:159]
  ds_read_b64_tr_b16 a[4:5], v2 offset:0
  ds_read_b64_tr_b16 a[6:7], v2 offset:512
  v_mfma_f32_16x16x32_bf16 v[184:187], v[176:179], a[16:19], 0
  s_nop 6
  v_mul_f32 v128, v128, v160
  v_mul_f32 v129, v129, v161
  v_mul_f32 v130, v130, v162
  v_mul_f32 v131, v131, v163
  v_mul_f32 v136, v136, v168
  v_mul_f32 v137, v137, v169
  v_mul_f32 v138, v138, v170
  v_mul_f32 v139, v139, v171
  v_mfma_f32_32x32x16_bf16 v[144:159], a[24:27], v[24:27], v[144:159]
  ds_read_b64_tr_b16 a[8:9], v3 offset:0
  ds_read_b64_tr_b16 a[10:11], v3 offset:512
  v_cvt_pk_bf16_f32 v128, v128, v129
  v_cvt_pk_bf16_f32 v129, v130, v131
  v_cvt_pk_bf16_f32 v130, v136, v137
  v_cvt_pk_bf16_f32 v131, v138, v139
  buffer_store_dwordx4 v[128:131], v202, s[60:63], s10 offen offset:0 sc1
  v_mul_f32 v132, v132, v164
  v_mul_f32 v133, v133, v165
  v_mul_f32 v134, v134, v166
  v_mul_f32 v135, v135, v167
  v_mfma_f32_32x32x16_bf16 v[144:159], a[28:31], v[28:31], v[144:159]
  ds_read_b64_tr_b16 a[12:13], v4 offset:0
  ds_read_b64_tr_b16 a[14:15], v4 offset:512
  v_mul_f32 v140, v140, v172
  v_mul_f32 v141, v141, v173
  v_mul_f32 v142, v142, v174
  v_mul_f32 v143, v143, v175
  v_cvt_pk_bf16_f32 v132, v132, v133
  v_cvt_pk_bf16_f32 v133, v134, v135
  v_cvt_pk_bf16_f32 v134, v140, v141
  v_cvt_pk_bf16_f32 v135, v142, v143
  buffer_store_dwordx4 v[132:135], v202, s[60:63], s10 offen offset:512 sc1
  s_waitcnt vmcnt(17)
  s_barrier
  s_waitcnt lgkmcnt(4)
  v_mfma_f32_32x32x16_bf16 v[144:159], a[0:3], v[32:35], v[144:159]
  ds_read_b64_tr_b16 a[16:17], v1 offset:8192
  ds_read_b64_tr_b16 a[18:19], v1 offset:8704
  s_add_u32 m0, s93, 81920
  s_nop 0
  buffer_load_dwordx4 v6, s[44:47], s89 offen lds
  s_waitcnt vmcnt(12)
  v_cmp_eq_u64 vcc, 0, v[14:15]
  s_cbranch_vccnz SLOW3
BACK3:
  s_lshl_b32 s13, s9, 7
  s_add_u32 s40, s20, s13
  s_addc_u32 s41, s21, 0
  s_sub_u32 s42, 401408, s13
  s_mov_b32 s43, 0x00020000
  s_and_b32 s101, s8, 1
  s_mul_i32 s101, s101, 3
  s_add_u32 s101, s101, s9
  s_sub_u32 s100, s101, 7
  s_cmp_ge_u32 s101, 7
  s_cselect_b32 s101, s100, s101
  s_add_u32 s13, s101, 0
  s_sub_u32 s100, s13, 7
  s_cmp_ge_u32 s13, 7
  s_cselect_b32 s13, s100, s13
  s_lshl_b32 s72, s13, 14
  s_add_u32 s72, s72, s59
  s_mul_i32 s79, s13, 229376
  v_mfma_f32_32x32x16_bf16 v[144:159], a[4:7], v[36:39], v[144:159]
  ds_read_b64_tr_b16 a[20:21], v2 offset:8192
  ds_read_b64_tr_b16 a[22:23], v2 offset:8704
  s_add_u32 m0, s93, 90112
  s_nop 0
  buffer_load_dwordx4 v6, s[44:47], s90 offen lds
  v_mfma_f32_16x16x32_bf16 v[184:187], v[176:179], a[0:3], v[184:187]
  s_add_u32 s13, s101, 1
  s_sub_u32 s100, s13, 7
  s_cmp_ge_u32 s13, 7
  s_cselect_b32 s13, s100, s13
  s_lshl_b32 s73, s13, 14
  s_add_u32 s73, s73, s59
  s_mul_i32 s80, s13, 229376
  s_waitcnt lgkmcnt(4)
  v_mfma_f32_32x32x16_bf16 v[144:159], a[8:11], v[40:43], v[144:159]
  ds_read_b64_tr_b16 a[24:25], v3 offset:8192
  ds_read_b64_tr_b16 a[26:27], v3 offset:8704
  s_add_u32 s13, s101, 2
  s_sub_u32 s100, s13, 7
  s_cmp_ge_u32 s13, 7
  s_cselect_b32 s13, s100, s13
  s_lshl_b32 s74, s13, 14
  s_add_u32 s74, s74, s59
  s_mul_i32 s81, s13, 229376
  v_mfma_f32_32x32x16_bf16 v[144:159], a[12:15], v[44:47], v[144:159]
  ds_read_b64_tr_b16 a[28:29], v4 offset:8192
  ds_read_b64_tr_b16 a[30:31], v4 offset:8704
  s_add_u32 s13, s101, 3
  s_sub_u32 s100, s13, 7
  s_cmp_ge_u32 s13, 7
  s_cselect_b32 s13, s100, s13
  s_lshl_b32 s75, s13, 14
  s_add_u32 s75, s75, s59
  s_mul_i32 s82, s13, 229376
  s_barrier
  s_waitcnt lgkmcnt(4)
  v_mfma_f32_32x32x16_bf16 v[144:159], a[16:19], v[48:51], v[144:159]
  ds_read_b64_tr_b16 a[0:1], v1 offset:32768
  ds_read_b64_tr_b16 a[2:3], v1 offset:33280
  s_add_u32 s13, s101, 4
  s_sub_u32 s100, s13, 7
  s_cmp_ge_u32 s13, 7
  s_cselect_b32 s13, s100, s13
  s_lshl_b32 s76, s13, 14
  s_add_u32 s76, s76, s59
  s_mul_i32 s83, s13, 229376
  v_mfma_f32_32x32x16_bf16 v[144:159], a[20:23], v[52:55], v[144:159]
  ds_read_b64_tr_b16 a[4:5], v2 offset:32768
  ds_read_b64_tr_b16 a[6:7], v2 offset:33280
  v_mfma_f32_16x16x32_bf16 v[184:187], v[176:179], a[16:19], v[184:187]
  s_add_u32 s13, s101, 5
  s_sub_u32 s100, s13, 7
  s_cmp_ge_u32 s13, 7
  s_cselect_b32 s13, s100, s13
  s_lshl_b32 s77, s13, 14
  s_add_u32 s77, s77, s59
  s_mul_i32 s84, s13, 229376
  s_waitcnt lgkmcnt(4)
  v_mfma_f32_32x32x16_bf16 v[144:159], a[24:27], v[56:59], v[144:159]
  ds_read_b64_tr_b16 a[8:9], v3 offset:32768
  ds_read_b64_tr_b16 a[10:11], v3 offset:33280
  s_add_u32 s13, s101, 6
  s_sub_u32 s100, s13, 7
  s_cmp_ge_u32 s13, 7
  s_cselect_b32 s13, s100, s13
  s_lshl_b32 s78, s13, 14
  s_add_u32 s78, s78, s59
  s_mul_i32 s85, s13, 229376
  v_mfma_f32_32x32x16_bf16 v[144:159], a[28:31], v[60:63], v[144:159]
  ds_read_b64_tr_b16 a[12:13], v4 offset:32768
  ds_read_b64_tr_b16 a[14:15], v4 offset:33280
  s_barrier
  s_waitcnt lgkmcnt(4)
  v_mfma_f32_32x32x16_bf16 v[144:159], a[0:3], v[64:67], v[144:159]
  ds_read_b64_tr_b16 a[16:17], v1 offset:40960
  ds_read_b64_tr_b16 a[18:19], v1 offset:41472
  v_mfma_f32_32x32x16_bf16 v[144:159], a[4:7], v[68:71], v[144:159]
  ds_read_b64_tr_b16 a[20:21], v2 offset:40960
  ds_read_b64_tr_b16 a[22:23], v2 offset:41472
  v_mfma_f32_16x16x32_bf16 v[184:187], v[176:179], a[0:3], v[184:187]
  s_waitcnt vmcnt(2)
  s_mov_b64 exec, 1
  buffer_store_dwordx2 v[14:15], off, s[60:63], s14 offset:0 sc1
  s_mov_b64 exec, -1
  s_waitcnt lgkmcnt(4)
  v_mfma_f32_32x32x16_bf16 v[144:159], a[8:11], v[72:75], v[144:159]
  ds_read_b64_tr_b16 a[24:25], v3 offset:40960
  ds_read_b64_tr_b16 a[26:27], v3 offset:41472
  v_mfma_f32_32x32x16_bf16 v[144:159], a[12:15], v[76:79], v[144:159]
  ds_read_b64_tr_b16 a[28:29], v4 offset:40960
  ds_read_b64_tr_b16 a[30:31], v4 offset:41472
  s_waitcnt lgkmcnt(4)
  v_mfma_f32_32x32x16_bf16 v[144:159], a[16:19], v[80:83], v[144:159]
  v_add_u32 v1, 4294901760, v1
  ds_read_b64_tr_b16 a[0:1], v1 offset:0
  ds_read_b64_tr_b16 a[2:3], v1 offset:512
  v_mfma_f32_32x32x16_bf16 v[144:159], a[20:23], v[84:87], v[144:159]
  v_add_u32 v2, 4294901760, v2
  ds_read_b64_tr_b16 a[4:5], v2 offset:0
  ds_read_b64_tr_b16 a[6:7], v2 offset:512
  v_mfma_f32_16x16x32_bf16 v[184:187], v[176:179], a[16:19], v[184:187]
  s_waitcnt lgkmcnt(4)
  v_mfma_f32_32x32x16_bf16 v[144:159], a[24:27], v[88:91], v[144:159]
  v_add_u32 v3, 4294901760, v3
  ds_read_b64_tr_b16 a[8:9], v3 offset:0
  ds_read_b64_tr_b16 a[10:11], v3 offset:512
  s_add_u32 m0, s94, 65536
  s_add_u32 s100, s7, 0
  buffer_load_dwordx4 v196, s[40:43], s100 offen offset:0 lds
  v_mfma_f32_32x32x16_bf16 v[144:159], a[28:31], v[92:95], v[144:159]
  v_add_u32 v4, 4294901760, v4
  ds_read_b64_tr_b16 a[12:13], v4 offset:0
  ds_read_b64_tr_b16 a[14:15], v4 offset:512
  s_barrier
  s_waitcnt lgkmcnt(4)
  v_mfma_f32_32x32x16_bf16 v[144:159], a[0:3], v[96:99], v[144:159]
  ds_read_b64_tr_b16 a[16:17], v1 offset:8192
  ds_read_b64_tr_b16 a[18:19], v1 offset:8704
  v_mfma_f32_32x32x16_bf16 v[144:159], a[4:7], v[100:103], v[144:159]
  ds_read_b64_tr_b16 a[20:21], v2 offset:8192
  ds_read_b64_tr_b16 a[22:23], v2 offset:8704
  v_mfma_f32_16x16x32_bf16 v[184:187], v[176:179], a[0:3], v[184:187]
  s_waitcnt lgkmcnt(4)
  v_mfma_f32_32x32x16_bf16 v[144:159], a[8:11], v[104:107], v[144:159]
  ds_read_b64_tr_b16 a[24:25], v3 offset:8192
  ds_read_b64_tr_b16 a[26:27], v3 offset:8704
  s_add_u32 m0, s94, 65536
  s_add_u32 s100, s7, 0
  buffer_load_dwordx4 v197, s[40:43], s100 offen offset:1024 lds
  v_mfma_f32_32x32x16_bf16 v[144:159], a[12:15], v[108:111], v[144:159]
  ds_read_b64_tr_b16 a[28:29], v4 offset:8192
  ds_read_b64_tr_b16 a[30:31], v4 offset:8704
  s_waitcnt lgkmcnt(4)
  v_mfma_f32_32x32x16_bf16 v[144:159], a[16:19], v[112:115], v[144:159]
  v_add_u32 v1, 131072, v1
  ds_read_b64_tr_b16 a[0:1], v1 offset:0
  ds_read_b64_tr_b16 a[2:3], v1 offset:512
  v_mfma_f32_32x32x16_bf16 v[144:159], a[20:23], v[116:119], v[144:159]
  v_add_u32 v2, 131072, v2
  ds_read_b64_tr_b16 a[4:5], v2 offset:0
  ds_read_b64_tr_b16 a[6:7], v2 offset:512
  v_mfma_f32_16x16x32_bf16 v[184:187], v[176:179], a[16:19], v[184:187]
  s_waitcnt lgkmcnt(4)
  v_mfma_f32_32x32x16_bf16 v[144:159], a[24:27], v[120:123], v[144:159]
  v_add_u32 v3, 131072, v3
  ds_read_b64_tr_b16 a[8:9], v3 offset:0
  ds_read_b64_tr_b16 a[10:11], v3 offset:512
  s_add_u32 m0, s94, 98304
  s_add_u32 s100, s7, 229376
  buffer_load_dwordx4 v196, s[40:43], s100 offen offset:0 lds
  v_mfma_f32_32x32x16_bf16 v[144:159], a[28:31], v[124:127], v[144:159]
  v_add_u32 v4, 131072, v4
  ds_read_b64_tr_b16 a[12:13], v4 offset:0
  ds_read_b64_tr_b16 a[14:15], v4 offset:512
  ds_write_b32 v12, v184
  s_waitcnt lgkmcnt(0)
  s_barrier
  ds_read_b128 v[188:191], v11
  v_mfma_f32_32x32x16_bf16 v[160:175], a[0:3], v[16:19], 0
  ds_read_b64_tr_b16 a[16:17], v1 offset:8192
  ds_read_b64_tr_b16 a[18:19], v1 offset:8704
  v_mfma_f32_32x32x16_bf16 v[160:175], a[4:7], v[20:23], v[160:175]
  ds_read_b64_tr_b16 a[20:21], v2 offset:8192
  ds_read_b64_tr_b16 a[22:23], v2 offset:8704
  v_mfma_f32_16x16x32_bf16 v[184:187], v[176:179], a[0:3], 0
  s_waitcnt lgkmcnt(4)
  v_add_f32 v188, v188, v189
  v_add_f32 v190, v190, v191
  v_add_f32 v188, v188, v190
  v_and_b32 v189, 0xffff0000, v188
  v_sub_f32 v188, v188, v189
  v_cvt_pk_bf16_f32 v182, v189, v188
  s_nop 1
  v_mfma_f32_32x32x8_bf16 v[144:159], v[182:183], v[180:181], v[144:159]
  v_mfma_f32_32x32x16_bf16 v[160:175], a[8:11], v[24:27], v[160:175]
  ds_read_b64_tr_b16 a[24:25], v3 offset:8192
  ds_read_b64_tr_b16 a[26:27], v3 offset:8704
  s_add_u32 m0, s94, 98304
  s_add_u32 s100, s7, 229376
  buffer_load_dwordx4 v197, s[40:43], s100 offen offset:1024 lds
  v_mfma_f32_32x32x16_bf16 v[160:175], a[12:15], v[28:31], v[160:175]
  ds_read_b64_tr_b16 a[28:29], v4 offset:8192
  ds_read_b64_tr_b16 a[30:31], v4 offset:8704
  s_nop 2
  v_mul_f32 v192, v144, v8
  v_mul_f32 v193, v145, v8
  v_mul_f32 v194, v146, v8
  v_mul_f32 v195, v147, v8
  s_waitcnt lgkmcnt(4)
  v_mfma_f32_32x32x16_bf16 v[160:175], a[16:19], v[32:35], v[160:175]
  v_add_u32 v1, 4294836224, v1
  ds_read_b64_tr_b16 a[0:1], v1 offset:16384
  ds_read_b64_tr_b16 a[2:3], v1 offset:16896
  v_exp_f32 v192, v192
  v_exp_f32 v193, v193
  v_exp_f32 v194, v194
  v_mfma_f32_32x32x16_bf16 v[160:175], a[20:23], v[36:39], v[160:175]
  v_add_u32 v2, 4294836224, v2
  ds_read_b64_tr_b16 a[4:5], v2 offset:16384
  ds_read_b64_tr_b16 a[6:7], v2 offset:16896
  v_mfma_f32_16x16x32_bf16 v[184:187], v[176:179], a[16:19], v[184:187]
  v_exp_f32 v195, v195
  v_fma_f32 v192, v192, v9, v9
  v_fma_f32 v193, v193, v9, v9
  v_fma_f32 v194, v194, v9, v9
  s_waitcnt lgkmcnt(4)
  v_mfma_f32_32x32x16_bf16 v[160:175], a[24:27], v[40:43], v[160:175]
  v_add_u32 v3, 4294836224, v3
  ds_read_b64_tr_b16 a[8:9], v3 offset:16384
  ds_read_b64_tr_b16 a[10:11], v3 offset:16896
  s_add_u32 m0, s94, 0
  s_add_u32 s100, s97, s79
  buffer_load_dwordx4 v196, s[52:55], s100 offen offset:0 lds
  v_fma_f32 v195, v195, v9, v9
  v_rcp_f32 v192, v192
  v_rcp_f32 v193, v193
  v_mfma_f32_32x32x16_bf16 v[160:175], a[28:31], v[44:47], v[160:175]
  v_add_u32 v4, 4294836224, v4
  ds_read_b64_tr_b16 a[12:13], v4 offset:16384
  ds_read_b64_tr_b16 a[14:15], v4 offset:16896
  v_rcp_f32 v194, v194
  v_rcp_f32 v195, v195
  v_mul_f32 v144, v144, v192
  v_mul_f32 v145, v145, v193
  s_barrier
  s_waitcnt lgkmcnt(4)
  v_mfma_f32_32x32x16_bf16 v[160:175], a[0:3], v[48:51], v[160:175]
  ds_read_b64_tr_b16 a[16:17], v1 offset:24576
  ds_read_b64_tr_b16 a[18:19], v1 offset:25088
  v_mul_f32 v146, v146, v194
  v_mul_f32 v147, v147, v195
  v_mul_f32 v188, v148, v8
  v_mul_f32 v189, v149, v8
  v_mul_f32 v190, v150, v8
  v_mfma_f32_32x32x16_bf16 v[160:175], a[4:7], v[52:55], v[160:175]
  ds_read_b64_tr_b16 a[20:21], v2 offset:24576
  ds_read_b64_tr_b16 a[22:23], v2 offset:25088
  v_mfma_f32_16x16x32_bf16 v[184:187], v[176:179], a[0:3], v[184:187]
  v_mul_f32 v191, v151, v8
  v_exp_f32 v188, v188
  v_exp_f32 v189, v189
  s_waitcnt lgkmcnt(4)
  v_mfma_f32_32x32x16_bf16 v[160:175], a[8:11], v[56:59], v[160:175]
  ds_read_b64_tr_b16 a[24:25], v3 offset:24576
  ds_read_b64_tr_b16 a[26:27], v3 offset:25088
  s_add_u32 m0, s94, 0
  s_add_u32 s100, s97, s79
  buffer_load_dwordx4 v197, s[52:55], s100 offen offset:1024 lds
  v_exp_f32 v190, v190
  v_exp_f32 v191, v191
  v_fma_f32 v188, v188, v9, v9
  v_fma_f32 v189, v189, v9, v9
  v_mfma_f32_32x32x16_bf16 v[160:175], a[12:15], v[60:63], v[160:175]
  ds_read_b64_tr_b16 a[28:29], v4 offset:24576
  ds_read_b64_tr_b16 a[30:31], v4 offset:25088
  v_fma_f32 v190, v190, v9, v9
  v_fma_f32 v191, v191, v9, v9
  v_rcp_f32 v188, v188
  v_rcp_f32 v189, v189
  s_waitcnt lgkmcnt(4)
  v_mfma_f32_32x32x16_bf16 v[160:175], a[16:19], v[64:67], v[160:175]
  ds_read_b64_tr_b16 a[0:1], v1 offset:32768
  ds_read_b64_tr_b16 a[2:3], v1 offset:33280
  v_rcp_f32 v190, v190
  v_rcp_f32 v191, v191
  v_mul_f32 v148, v148, v188
  v_mfma_f32_32x32x16_bf16 v[160:175], a[20:23], v[68:71], v[160:175]
  ds_read_b64_tr_b16 a[4:5], v2 offset:32768
  ds_read_b64_tr_b16 a[6:7], v2 offset:33280
  v_mfma_f32_16x16x32_bf16 v[184:187], v[176:179], a[16:19], v[184:187]
  v_mul_f32 v149, v149, v189
  v_mul_f32 v150, v150, v190
  v_mul_f32 v151, v151, v191
  v_mul_f32 v192, v152, v8
  v_mul_f32 v193, v153, v8
  s_waitcnt lgkmcnt(4)
  v_mfma_f32_32x32x16_bf16 v[160:175], a[24:27], v[72:75], v[160:175]
  ds_read_b64_tr_b16 a[8:9], v3 offset:32768
  ds_read_b64_tr_b16 a[10:11], v3 offset:33280
  v_mul_f32 v194, v154, v8
  v_mul_f32 v195, v155, v8
  v_exp_f32 v192, v192
  v_exp_f32 v193, v193
  v_mfma_f32_32x32x16_bf16 v[160:175], a[28:31], v[76:79], v[160:175]
  ds_read_b64_tr_b16 a[12:13], v4 offset:32768
  ds_read_b64_tr_b16 a[14:15], v4 offset:33280
  v_exp_f32 v194, v194
  v_exp_f32 v195, v195
  v_fma_f32 v192, v192, v9, v9
  s_barrier
  s_waitcnt lgkmcnt(4)
  v_mfma_f32_32x32x16_bf16 v[160:175], a[0:3], v[80:83], v[160:175]
  ds_read_b64_tr_b16 a[16:17], v1 offset:40960
  ds_read_b64_tr_b16 a[18:19], v1 offset:41472
  v_fma_f32 v193, v193, v9, v9
  v_fma_f32 v194, v194, v9, v9
  v_fma_f32 v195, v195, v9, v9
  v_rcp_f32 v192, v192
  v_mfma_f32_32x32x16_bf16 v[160:175], a[4:7], v[84:87], v[160:175]
  ds_read_b64_tr_b16 a[20:21], v2 offset:40960
  ds_read_b64_tr_b16 a[22:23], v2 offset:41472
  v_mfma_f32_16x16x32_bf16 v[184:187], v[176:179], a[0:3], v[184:187]
  v_rcp_f32 v193, v193
  v_rcp_f32 v194, v194
  v_rcp_f32 v195, v195
  s_waitcnt lgkmcnt(4)
  v_mfma_f32_32x32x16_bf16 v[160:175], a[8:11], v[88:91], v[160:175]
  ds_read_b64_tr_b16 a[24:25], v3 offset:40960
  ds_read_b64_tr_b16 a[26:27], v3 offset:41472
  s_add_u32 m0, s94, 16384
  s_add_u32 s100, s97, s80
  buffer_load_dwordx4 v196, s[52:55], s100 offen offset:0 lds
  v_mul_f32 v152, v152, v192
  v_mul_f32 v153, v153, v193
  v_mul_f32 v154, v154, v194
  v_mul_f32 v155, v155, v195
  v_mul_f32 v188, v156, v8
  v_mfma_f32_32x32x16_bf16 v[160:175], a[12:15], v[92:95], v[160:175]
  ds_read_b64_tr_b16 a[28:29], v4 offset:40960
  ds_read_b64_tr_b16 a[30:31], v4 offset:41472
  v_mul_f32 v189, v157, v8
  v_mul_f32 v190, v158, v8
  v_mul_f32 v191, v159, v8
  v_exp_f32 v188, v188
  s_waitcnt lgkmcnt(4)
  v_mfma_f32_32x32x16_bf16 v[160:175], a[16:19], v[96:99], v[160:175]
  v_add_u32 v1, 65536, v1
  ds_read_b64_tr_b16 a[0:1], v1 offset:49152
  ds_read_b64_tr_b16 a[2:3], v1 offset:49664
  v_exp_f32 v189, v189
  v_exp_f32 v190, v190
  v_exp_f32 v191, v191
  v_mfma_f32_32x32x16_bf16 v[160:175], a[20:23], v[100:103], v[160:175]
  v_add_u32 v2, 65536, v2
  ds_read_b64_tr_b16 a[4:5], v2 offset:49152
  ds_read_b64_tr_b16 a[6:7], v2 offset:49664
  v_mfma_f32_16x16x32_bf16 v[184:187], v[176:179], a[16:19], v[184:187]
  v_fma_f32 v188, v188, v9, v9
  v_fma_f32 v189, v189, v9, v9
  v_fma_f32 v190, v190, v9, v9
  v_fma_f32 v191, v191, v9, v9
  v_rcp_f32 v188, v188
  s_waitcnt lgkmcnt(4)
  v_mfma_f32_32x32x16_bf16 v[160:175], a[24:27], v[104:107], v[160:175]
  v_add_u32 v3, 65536, v3
  ds_read_b64_tr_b16 a[8:9], v3 offset:49152
  ds_read_b64_tr_b16 a[10:11], v3 offset:49664
  s_add_u32 m0, s94, 16384
  s_add_u32 s100, s97, s80
  buffer_load_dwordx4 v197, s[52:55], s100 offen offset:1024 lds
  v_rcp_f32 v189, v189
  v_rcp_f32 v190, v190
  v_mfma_f32_32x32x16_bf16 v[160:175], a[28:31], v[108:111], v[160:175]
  v_add_u32 v4, 65536, v4
  ds_read_b64_tr_b16 a[12:13], v4 offset:49152
  ds_read_b64_tr_b16 a[14:15], v4 offset:49664
  v_rcp_f32 v191, v191
  v_mul_f32 v156, v156, v188
  v_mul_f32 v157, v157, v189
  v_mul_f32 v158, v158, v190
  v_mul_f32 v159, v159, v191
  ds_write_b32 v12, v184
  s_waitcnt lgkmcnt(0)
  s_barrier
  v_mfma_f32_32x32x16_bf16 v[160:175], a[0:3], v[112:115], v[160:175]
  ds_read_b64_tr_b16 a[16:17], v1 offset:57344
  ds_read_b64_tr_b16 a[18:19], v1 offset:57856
  s_add_u32 m0, s93, 32768
  s_nop 0
  buffer_load_dwordx4 v6, s[44:47], s91 offen lds
  v_mfma_f32_16x16x32_bf16 v[184:187], v[176:179], a[0:3], 0
  v_mfma_f32_32x32x16_bf16 v[160:175], a[4:7], v[116:119], v[160:175]
  ds_read_b64_tr_b16 a[20:21], v2 offset:57344
  ds_read_b64_tr_b16 a[22:23], v2 offset:57856
  s_add_u32 m0, s93, 40960
  s_nop 0
  buffer_load_dwordx4 v6, s[44:47], s92 offen lds
  v_mfma_f32_16x16x32_bf16 v[184:187], v[176:179], a[4:7], v[184:187]
  v_mfma_f32_32x32x16_bf16 v[160:175], a[8:11], v[120:123], v[160:175]
  ds_read_b64_tr_b16 a[24:25], v3 offset:57344
  ds_read_b64_tr_b16 a[26:27], v3 offset:57856
  v_mfma_f32_16x16x32_bf16 v[184:187], v[176:179], a[8:11], v[184:187]
  ds_read_b128 v[188:191], v11
  v_mfma_f32_32x32x16_bf16 v[160:175], a[12:15], v[124:127], v[160:175]
  ds_read_b64_tr_b16 a[28:29], v4 offset:57344
  ds_read_b64_tr_b16 a[30:31], v4 offset:57856
  v_mfma_f32_16x16x32_bf16 v[184:187], v[176:179], a[12:15], v[184:187]
  s_waitcnt lgkmcnt(5)
  v_mfma_f32_32x32x16_bf16 v[128:143], a[16:19], v[16:19], 0
  v_add_u32 v1, 4294901760, v1
  ds_read_b64_tr_b16 a[0:1], v1 offset:49152
  ds_read_b64_tr_b16 a[2:3], v1 offset:49664
  s_waitcnt lgkmcnt(4)
  v_add_f32 v188, v188, v189
  v_add_f32 v190, v190, v191
  v_add_f32 v188, v188, v184
  v_add_f32 v188, v188, v190
  v_and_b32 v189, 0xffff0000, v188
  v_sub_f32 v188, v188, v189
  v_cvt_pk_bf16_f32 v182, v189, v188
  s_nop 1
  v_mfma_f32_32x32x8_bf16 v[160:175], v[182:183], v[180:181], v[160:175]
  v_mfma_f32_32x32x16_bf16 v[128:143], a[20:23], v[20:23], v[128:143]
  v_add_u32 v2, 4294901760, v2
  ds_read_b64_tr_b16 a[4:5], v2 offset:49152
  ds_read_b64_tr_b16 a[6:7], v2 offset:49664
  v_mfma_f32_16x16x32_bf16 v[184:187], v[176:179], a[16:19], 0
  s_waitcnt lgkmcnt(4)
  v_mfma_f32_32x32x16_bf16 v[128:143], a[24:27], v[24:27], v[128:143]
  v_add_u32 v3, 4294901760, v3
  ds_read_b64_tr_b16 a[8:9], v3 offset:49152
  ds_read_b64_tr_b16 a[10:11], v3 offset:49664
  s_nop 1
  v_mul_f32 v160, v160, v144
  v_mul_f32 v161, v161, v145
  v_mul_f32 v162, v162, v146
  v_mul_f32 v163, v163, v147
  v_mfma_f32_32x32x16_bf16 v[128:143], a[28:31], v[28:31], v[128:143]
  v_add_u32 v4, 4294901760, v4
  ds_read_b64_tr_b16 a[12:13], v4 offset:49152
  ds_read_b64_tr_b16 a[14:15], v4 offset:49664
  v_mul_f32 v168, v168, v152
  v_mul_f32 v169, v169, v153
  v_mul_f32 v170, v170, v154
  v_mul_f32 v171, v171, v155
  s_waitcnt vmcnt(11)
  s_barrier
  s_waitcnt lgkmcnt(4)
  v_mfma_f32_32x32x16_bf16 v[128:143], a[0:3], v[32:35], v[128:143]
  ds_read_b64_tr_b16 a[16:17], v1 offset:57344
  ds_read_b64_tr_b16 a[18:19], v1 offset:57856
  s_add_u32 m0, s93, 114688
  s_ashr_i32 s15, s3, 31
  s_add_u32 s48, s48, s3
  s_addc_u32 s49, s49, s15
  s_sub_u32 s50, s50, s3
  buffer_load_dwordx4 v6, s[48:51], s86 offen lds
  v_cvt_pk_bf16_f32 v160, v160, v161
  v_cvt_pk_bf16_f32 v161, v162, v163
  v_cvt_pk_bf16_f32 v162, v168, v169
  v_cvt_pk_bf16_f32 v163, v170, v171
  buffer_store_dwordx4 v[160:163], v5, s[60:63], s11 offen offset:0 sc1
  v_mfma_f32_32x32x16_bf16 v[128:143], a[4:7], v[36:39], v[128:143]
  ds_read_b64_tr_b16 a[20:21], v2 offset:57344
  ds_read_b64_tr_b16 a[22:23], v2 offset:57856
  s_add_u32 m0, s93, 122880
  s_nop 0
  buffer_load_dwordx4 v6, s[48:51], s87 offen lds
  v_mfma_f32_16x16x32_bf16 v[184:187], v[176:179], a[0:3], v[184:187]
  v_mul_f32 v164, v164, v148
  v_mul_f32 v165, v165, v149
  v_mul_f32 v166, v166, v150
  v_mul_f32 v167, v167, v151
  s_waitcnt lgkmcnt(4)
  v_mfma_f32_32x32x16_bf16 v[128:143], a[8:11], v[40:43], v[128:143]
  ds_read_b64_tr_b16 a[24:25], v3 offset:57344
  ds_read_b64_tr_b16 a[26:27], v3 offset:57856
  v_mul_f32 v172, v172, v156
  v_mul_f32 v173, v173, v157
  v_mul_f32 v174, v174, v158
  v_mul_f32 v175, v175, v159
  v_cvt_pk_bf16_f32 v164, v164, v165
  v_mfma_f32_32x32x16_bf16 v[128:143], a[12:15], v[44:47], v[128:143]
  ds_read_b64_tr_b16 a[28:29], v4 offset:57344
  ds_read_b64_tr_b16 a[30:31], v4 offset:57856
  v_cvt_pk_bf16_f32 v165, v166, v167
  v_cvt_pk_bf16_f32 v166, v172, v173
  v_cvt_pk_bf16_f32 v167, v174, v175
  buffer_store_dwordx4 v[164:167], v5, s[60:63], s11 offen offset:1024 sc1
  s_waitcnt lgkmcnt(4)
  v_mfma_f32_32x32x16_bf16 v[128:143], a[16:19], v[48:51], v[128:143]
  v_add_u32 v1, 65536, v1
  ds_read_b64_tr_b16 a[0:1], v1 offset:16384
  ds_read_b64_tr_b16 a[2:3], v1 offset:16896
  v_mfma_f32_32x32x16_bf16 v[128:143], a[20:23], v[52:55], v[128:143]
  v_add_u32 v2, 65536, v2
  ds_read_b64_tr_b16 a[4:5], v2 offset:16384
  ds_read_b64_tr_b16 a[6:7], v2 offset:16896
  v_mfma_f32_16x16x32_bf16 v[184:187], v[176:179], a[16:19], v[184:187]
  s_waitcnt lgkmcnt(4)
  v_mfma_f32_32x32x16_bf16 v[128:143], a[24:27], v[56:59], v[128:143]
  v_add_u32 v3, 65536, v3
  ds_read_b64_tr_b16 a[8:9], v3 offset:16384
  ds_read_b64_tr_b16 a[10:11], v3 offset:16896
  v_mfma_f32_32x32x16_bf16 v[128:143], a[28:31], v[60:63], v[128:143]
  v_add_u32 v4, 65536, v4
  ds_read_b64_tr_b16 a[12:13], v4 offset:16384
  ds_read_b64_tr_b16 a[14:15], v4 offset:16896
  s_waitcnt vmcnt(4)
  s_barrier
  s_waitcnt lgkmcnt(4)
  v_mfma_f32_32x32x16_bf16 v[128:143], a[0:3], v[64:67], v[128:143]
  ds_read_b64_tr_b16 a[16:17], v1 offset:24576
  ds_read_b64_tr_b16 a[18:19], v1 offset:25088
  s_add_u32 m0, s93, 49152
  s_nop 0
  buffer_load_dwordx4 v6, s[48:51], s88 offen lds
  v_mfma_f32_32x32x16_bf16 v[128:143], a[4:7], v[68:71], v[128:143]
  ds_read_b64_tr_b16 a[20:21], v2 offset:24576
  ds_read_b64_tr_b16 a[22:23], v2 offset:25088
  s_add_u32 m0, s93, 57344
  s_nop 0
  buffer_load_dwordx4 v6, s[48:51], s89 offen lds
  v_mfma_f32_16x16x32_bf16 v[184:187], v[176:179], a[0:3], v[184:187]
  s_waitcnt lgkmcnt(4)
  v_mfma_f32_32x32x16_bf16 v[128:143], a[8:11], v[72:75], v[128:143]
  ds_read_b64_tr_b16 a[24:25], v3 offset:24576
  ds_read_b64_tr_b16 a[26:27], v3 offset:25088
  v_mfma_f32_32x32x16_bf16 v[128:143], a[12:15], v[76:79], v[128:143]
  ds_read_b64_tr_b16 a[28:29], v4 offset:24576
  ds_read_b64_tr_b16 a[30:31], v4 offset:25088
  s_waitcnt lgkmcnt(4)
  v_mfma_f32_32x32x16_bf16 v[128:143], a[16:19], v[80:83], v[128:143]
  v_add_u32 v1, 4294901760, v1
  ds_read_b64_tr_b16 a[0:1], v1 offset:32768
  ds_read_b64_tr_b16 a[2:3], v1 offset:33280
  v_mfma_f32_32x32x16_bf16 v[128:143], a[20:23], v[84:87], v[128:143]
  v_add_u32 v2, 4294901760, v2
  ds_read_b64_tr_b16 a[4:5], v2 offset:32768
  ds_read_b64_tr_b16 a[6:7], v2 offset:33280
  v_mfma_f32_16x16x32_bf16 v[184:187], v[176:179], a[16:19], v[184:187]
  s_lshr_b32 s10, s8, 1
  s_lshl_b32 s10, s10, 12
  s_and_b32 s13, s8, 1
  s_lshl_b32 s13, s13, 9
  s_add_u32 s10, s10, s13
  s_add_u32 s10, s10, 14680064
  v_and_b32 v13, 7, v0
  v_min_u32 v13, 6, v13
  v_lshlrev_b32 v13, 5, v13
  v_bfe_u32 v205, v0, 3, 1
  v_lshl_add_u32 v13, v205, 8, v13
  s_lshl_b32 s13, s4, 3
  v_add_u32 v13, s13, v13
  s_waitcnt lgkmcnt(4)
  v_mfma_f32_32x32x16_bf16 v[128:143], a[24:27], v[88:91], v[128:143]
  v_add_u32 v3, 4294901760, v3
  ds_read_b64_tr_b16 a[8:9], v3 offset:32768
  ds_read_b64_tr_b16 a[10:11], v3 offset:33280
  v_mfma_f32_32x32x16_bf16 v[128:143], a[28:31], v[92:95], v[128:143]
  v_add_u32 v4, 4294901760, v4
  ds_read_b64_tr_b16 a[12:13], v4 offset:32768
  ds_read_b64_tr_b16 a[14:15], v4 offset:33280
  s_waitcnt vmcnt(3)
  s_barrier
  s_waitcnt lgkmcnt(4)
  v_mfma_f32_32x32x16_bf16 v[128:143], a[0:3], v[96:99], v[128:143]
  ds_read_b64_tr_b16 a[16:17], v1 offset:40960
  ds_read_b64_tr_b16 a[18:19], v1 offset:41472
  s_add_u32 m0, s93, 131072
  s_nop 0
  buffer_load_dwordx4 v6, s[48:51], s90 offen lds
  v_mfma_f32_32x32x16_bf16 v[128:143], a[4:7], v[100:103], v[128:143]
  ds_read_b64_tr_b16 a[20:21], v2 offset:40960
  ds_read_b64_tr_b16 a[22:23], v2 offset:41472
  s_add_u32 m0, s93, 139264
  s_nop 0
  buffer_load_dwordx4 v6, s[48:51], s91 offen lds
  v_mfma_f32_16x16x32_bf16 v[184:187], v[176:179], a[0:3], v[184:187]
  s_waitcnt vmcnt(4)
  s_mov_b64 exec, 1
  buffer_store_dwordx2 v[14:15], off, s[60:63], s14 offset:1024 sc1
  s_mov_b64 exec, -1
  s_waitcnt lgkmcnt(4)
  v_mfma_f32_32x32x16_bf16 v[128:143], a[8:11], v[104:107], v[128:143]
  ds_read_b64_tr_b16 a[24:25], v3 offset:40960
  ds_read_b64_tr_b16 a[26:27], v3 offset:41472
  s_add_u32 m0, s94, 81920
  s_add_u32 s100, s7, 114688
  buffer_load_dwordx4 v196, s[40:43], s100 offen offset:0 lds
  s_add_u32 m0, s93, 155648
  s_nop 0
  buffer_load_dwordx4 v6, s[48:51], s92 offen lds
  s_mov_b32 s64, s30
  s_mov_b32 s65, s31
  s_mov_b32 s66, 1835008
  s_mov_b32 s67, 0x00020000
  v_mfma_f32_32x32x16_bf16 v[128:143], a[12:15], v[108:111], v[128:143]
  ds_read_b64_tr_b16 a[28:29], v4 offset:40960
  ds_read_b64_tr_b16 a[30:31], v4 offset:41472
  s_waitcnt lgkmcnt(4)
  v_mfma_f32_32x32x16_bf16 v[128:143], a[16:19], v[112:115], v[128:143]
  v_add_u32 v1, 65536, v1
  ds_read_b64_tr_b16 a[0:1], v1 offset:49152
  ds_read_b64_tr_b16 a[2:3], v1 offset:49664
  v_mfma_f32_32x32x16_bf16 v[128:143], a[20:23], v[116:119], v[128:143]
  v_add_u32 v2, 65536, v2
  ds_read_b64_tr_b16 a[4:5], v2 offset:49152
  ds_read_b64_tr_b16 a[6:7], v2 offset:49664
  v_mfma_f32_16x16x32_bf16 v[184:187], v[176:179], a[16:19], v[184:187]
  s_waitcnt lgkmcnt(4)
  v_mfma_f32_32x32x16_bf16 v[128:143], a[24:27], v[120:123], v[128:143]
  v_add_u32 v3, 65536, v3
  ds_read_b64_tr_b16 a[8:9], v3 offset:49152
  ds_read_b64_tr_b16 a[10:11], v3 offset:49664
  s_add_u32 m0, s94, 81920
  s_add_u32 s100, s7, 114688
  buffer_load_dwordx4 v197, s[40:43], s100 offen offset:1024 lds
  v_mfma_f32_32x32x16_bf16 v[128:143], a[28:31], v[124:127], v[128:143]
  v_add_u32 v4, 65536, v4
  ds_read_b64_tr_b16 a[12:13], v4 offset:49152
  ds_read_b64_tr_b16 a[14:15], v4 offset:49664
  s_cmp_lg_u32 s56, 0
  s_cbranch_scc1 P2S
  ds_write_b32 v12, v184
  s_waitcnt lgkmcnt(0)
  s_waitcnt vmcnt(6)
  s_barrier
  ds_read_b128 v[188:191], v11
  v_mfma_f32_32x32x16_bf16 v[144:159], a[0:3], v[16:19], 0
  ds_read_b64_tr_b16 a[16:17], v1 offset:57344
  ds_read_b64_tr_b16 a[18:19], v1 offset:57856
  v_mfma_f32_32x32x16_bf16 v[144:159], a[4:7], v[20:23], v[144:159]
  ds_read_b64_tr_b16 a[20:21], v2 offset:57344
  ds_read_b64_tr_b16 a[22:23], v2 offset:57856
  v_mfma_f32_16x16x32_bf16 v[184:187], v[176:179], a[0:3], 0
  s_waitcnt lgkmcnt(4)
  v_add_f32 v188, v188, v189
  v_add_f32 v190, v190, v191
  v_add_f32 v188, v188, v190
  v_and_b32 v189, 0xffff0000, v188
  v_sub_f32 v188, v188, v189
  v_cvt_pk_bf16_f32 v182, v189, v188
  s_nop 1
  v_mfma_f32_32x32x8_bf16 v[128:143], v[182:183], v[180:181], v[128:143]
  v_mfma_f32_32x32x16_bf16 v[144:159], a[8:11], v[24:27], v[144:159]
  ds_read_b64_tr_b16 a[24:25], v3 offset:57344
  ds_read_b64_tr_b16 a[26:27], v3 offset:57856
  s_add_u32 m0, s94, 32768
  s_add_u32 s100, s97, s81
  buffer_load_dwordx4 v196, s[52:55], s100 offen offset:0 lds
  v_mfma_f32_32x32x16_bf16 v[144:159], a[12:15], v[28:31], v[144:159]
  ds_read_b64_tr_b16 a[28:29], v4 offset:57344
  ds_read_b64_tr_b16 a[30:31], v4 offset:57856
  s_nop 2
  v_mul_f32 v192, v128, v8
  v_mul_f32 v193, v129, v8
  v_mul_f32 v194, v130, v8
  v_mul_f32 v195, v131, v8
  s_waitcnt lgkmcnt(4)
  v_mfma_f32_32x32x16_bf16 v[144:159], a[16:19], v[32:35], v[144:159]
  v_add_u32 v1, 4294901760, v1
  ds_read_b64_tr_b16 a[0:1], v1 offset:49152
  ds_read_b64_tr_b16 a[2:3], v1 offset:49664
  v_exp_f32 v192, v192
  v_exp_f32 v193, v193
  v_exp_f32 v194, v194
  v_mfma_f32_32x32x16_bf16 v[144:159], a[20:23], v[36:39], v[144:159]
  v_add_u32 v2, 4294901760, v2
  ds_read_b64_tr_b16 a[4:5], v2 offset:49152
  ds_read_b64_tr_b16 a[6:7], v2 offset:49664
  v_mfma_f32_16x16x32_bf16 v[184:187], v[176:179], a[16:19], v[184:187]
  v_exp_f32 v195, v195
  v_fma_f32 v192, v192, v9, v9
  v_fma_f32 v193, v193, v9, v9
  v_fma_f32 v194, v194, v9, v9
  s_waitcnt lgkmcnt(4)
  v_mfma_f32_32x32x16_bf16 v[144:159], a[24:27], v[40:43], v[144:159]
  v_add_u32 v3, 4294901760, v3
  ds_read_b64_tr_b16 a[8:9], v3 offset:49152
  ds_read_b64_tr_b16 a[10:11], v3 offset:49664
  s_add_u32 m0, s94, 32768
  s_add_u32 s100, s97, s81
  buffer_load_dwordx4 v197, s[52:55], s100 offen offset:1024 lds
  v_fma_f32 v195, v195, v9, v9
  v_rcp_f32 v192, v192
  v_rcp_f32 v193, v193
  v_mfma_f32_32x32x16_bf16 v[144:159], a[28:31], v[44:47], v[144:159]
  v_add_u32 v4, 4294901760, v4
  ds_read_b64_tr_b16 a[12:13], v4 offset:49152
  ds_read_b64_tr_b16 a[14:15], v4 offset:49664
  v_rcp_f32 v194, v194
  v_rcp_f32 v195, v195
  v_mul_f32 v128, v128, v192
  v_mul_f32 v129, v129, v193
  s_waitcnt vmcnt(6)
  s_barrier
  s_waitcnt lgkmcnt(4)
  v_mfma_f32_32x32x16_bf16 v[144:159], a[0:3], v[48:51], v[144:159]
  ds_read_b64_tr_b16 a[16:17], v1 offset:57344
  ds_read_b64_tr_b16 a[18:19], v1 offset:57856
  buffer_load_dwordx2 v[6:7], v13, s[60:63], s10 offen offset:1024 sc1
  v_mul_f32 v130, v130, v194
  v_mul_f32 v131, v131, v195
  v_mul_f32 v188, v132, v8
  v_mul_f32 v189, v133, v8
  v_mul_f32 v190, v134, v8
  v_mfma_f32_32x32x16_bf16 v[144:159], a[4:7], v[52:55], v[144:159]
  ds_read_b64_tr_b16 a[20:21], v2 offset:57344
  ds_read_b64_tr_b16 a[22:23], v2 offset:57856
  v_mfma_f32_16x16x32_bf16 v[184:187], v[176:179], a[0:3], v[184:187]
  v_mul_f32 v191, v135, v8
  v_exp_f32 v188, v188
  v_exp_f32 v189, v189
  s_waitcnt lgkmcnt(4)
  v_mfma_f32_32x32x16_bf16 v[144:159], a[8:11], v[56:59], v[144:159]
  ds_read_b64_tr_b16 a[24:25], v3 offset:57344
  ds_read_b64_tr_b16 a[26:27], v3 offset:57856
  s_add_u32 m0, s94, 114688
  s_add_u32 s100, s7, 344064
  buffer_load_dwordx4 v196, s[40:43], s100 offen offset:0 lds
  v_exp_f32 v190, v190
  v_exp_f32 v191, v191
  v_fma_f32 v188, v188, v9, v9
  v_fma_f32 v189, v189, v9, v9
  v_mfma_f32_32x32x16_bf16 v[144:159], a[12:15], v[60:63], v[144:159]
  ds_read_b64_tr_b16 a[28:29], v4 offset:57344
  ds_read_b64_tr_b16 a[30:31], v4 offset:57856
  v_fma_f32 v190, v190, v9, v9
  v_fma_f32 v191, v191, v9, v9
  v_rcp_f32 v188, v188
  v_rcp_f32 v189, v189
  s_waitcnt lgkmcnt(4)
  v_mfma_f32_32x32x16_bf16 v[144:159], a[16:19], v[64:67], v[144:159]
  v_add_u32 v1, 131072, v1
  ds_read_b64_tr_b16 a[0:1], v1 offset:0
  ds_read_b64_tr_b16 a[2:3], v1 offset:512
  s_add_u32 m0, s94, 114688
  s_add_u32 s100, s7, 344064
  buffer_load_dwordx4 v197, s[40:43], s100 offen offset:1024 lds
  v_rcp_f32 v190, v190
  v_rcp_f32 v191, v191
  v_mul_f32 v132, v132, v188
  v_mfma_f32_32x32x16_bf16 v[144:159], a[20:23], v[68:71], v[144:159]
  v_add_u32 v2, 131072, v2
  ds_read_b64_tr_b16 a[4:5], v2 offset:0
  ds_read_b64_tr_b16 a[6:7], v2 offset:512
  v_mfma_f32_16x16x32_bf16 v[184:187], v[176:179], a[16:19], v[184:187]
  v_mul_f32 v133, v133, v189
  v_mul_f32 v134, v134, v190
  v_mul_f32 v135, v135, v191
  v_mul_f32 v192, v136, v8
  v_mul_f32 v193, v137, v8
  s_waitcnt lgkmcnt(4)
  v_mfma_f32_32x32x16_bf16 v[144:159], a[24:27], v[72:75], v[144:159]
  v_add_u32 v3, 131072, v3
  ds_read_b64_tr_b16 a[8:9], v3 offset:0
  ds_read_b64_tr_b16 a[10:11], v3 offset:512
  v_mul_f32 v194, v138, v8
  v_mul_f32 v195, v139, v8
  v_exp_f32 v192, v192
  v_exp_f32 v193, v193
  v_mfma_f32_32x32x16_bf16 v[144:159], a[28:31], v[76:79], v[144:159]
  v_add_u32 v4, 131072, v4
  ds_read_b64_tr_b16 a[12:13], v4 offset:0
  ds_read_b64_tr_b16 a[14:15], v4 offset:512
  v_exp_f32 v194, v194
  v_exp_f32 v195, v195
  v_fma_f32 v192, v192, v9, v9
  s_waitcnt vmcnt(6)
  s_barrier
  s_waitcnt lgkmcnt(4)
  v_mfma_f32_32x32x16_bf16 v[144:159], a[0:3], v[80:83], v[144:159]
  ds_read_b64_tr_b16 a[16:17], v1 offset:8192
  ds_read_b64_tr_b16 a[18:19], v1 offset:8704
  s_add_u32 m0, s94, 49152
  s_add_u32 s100, s97, s82
  buffer_load_dwordx4 v196, s[52:55], s100 offen offset:0 lds
  v_fma_f32 v193, v193, v9, v9
  v_fma_f32 v194, v194, v9, v9
  v_fma_f32 v195, v195, v9, v9
  v_rcp_f32 v192, v192
  v_mfma_f32_32x32x16_bf16 v[144:159], a[4:7], v[84:87], v[144:159]
  ds_read_b64_tr_b16 a[20:21], v2 offset:8192
  ds_read_b64_tr_b16 a[22:23], v2 offset:8704
  v_mfma_f32_16x16x32_bf16 v[184:187], v[176:179], a[0:3], v[184:187]
  v_rcp_f32 v193, v193
  v_rcp_f32 v194, v194
  v_rcp_f32 v195, v195
  s_waitcnt lgkmcnt(4)
  v_mfma_f32_32x32x16_bf16 v[144:159], a[8:11], v[88:91], v[144:159]
  ds_read_b64_tr_b16 a[24:25], v3 offset:8192
  ds_read_b64_tr_b16 a[26:27], v3 offset:8704
  s_add_u32 m0, s94, 49152
  s_add_u32 s100, s97, s82
  buffer_load_dwordx4 v197, s[52:55], s100 offen offset:1024 lds
  v_mul_f32 v136, v136, v192
  v_mul_f32 v137, v137, v193
  v_mul_f32 v138, v138, v194
  v_mul_f32 v139, v139, v195
  v_mul_f32 v188, v140, v8
  v_mfma_f32_32x32x16_bf16 v[144:159], a[12:15], v[92:95], v[144:159]
  ds_read_b64_tr_b16 a[28:29], v4 offset:8192
  ds_read_b64_tr_b16 a[30:31], v4 offset:8704
  s_waitcnt vmcnt(4)
  v_cmp_ne_u64 vcc, v[6:7], v[14:15]
  s_cbranch_vccnz SLOW4
BACK4:
  v_mul_f32 v189, v141, v8
  v_mul_f32 v190, v142, v8
  v_mul_f32 v191, v143, v8
  v_exp_f32 v188, v188
  s_waitcnt lgkmcnt(4)
  v_mfma_f32_32x32x16_bf16 v[144:159], a[16:19], v[96:99], v[144:159]
  ds_read_b64_tr_b16 a[0:1], v1 offset:24576
  ds_read_b64_tr_b16 a[2:3], v1 offset:25088
  s_add_u32 s101, s72, 0
  buffer_load_dwordx4 v[16:19], v5, s[60:63], s101 offen offset:0 sc1
  buffer_load_dwordx4 v[20:23], v5, s[60:63], s101 offen offset:1024 sc1
  s_add_u32 s101, s72, 143488
  buffer_load_dwordx4 v[24:27], v5, s[60:63], s101 offen offset:0 sc1
  buffer_load_dwordx4 v[28:31], v5, s[60:63], s101 offen offset:1024 sc1
  v_exp_f32 v189, v189
  v_exp_f32 v190, v190
  v_exp_f32 v191, v191
  v_mfma_f32_32x32x16_bf16 v[144:159], a[20:23], v[100:103], v[144:159]
  ds_read_b64_tr_b16 a[4:5], v2 offset:24576
  ds_read_b64_tr_b16 a[6:7], v2 offset:25088
  v_mfma_f32_16x16x32_bf16 v[184:187], v[176:179], a[16:19], v[184:187]
  v_fma_f32 v188, v188, v9, v9
  v_fma_f32 v189, v189, v9, v9
  v_fma_f32 v190, v190, v9, v9
  v_fma_f32 v191, v191, v9, v9
  v_rcp_f32 v188, v188
  s_waitcnt lgkmcnt(4)
  v_mfma_f32_32x32x16_bf16 v[144:159], a[24:27], v[104:107], v[144:159]
  ds_read_b64_tr_b16 a[8:9], v3 offset:24576
  ds_read_b64_tr_b16 a[10:11], v3 offset:25088
  s_add_u32 s101, s73, 0
  buffer_load_dwordx4 v[32:35], v5, s[60:63], s101 offen offset:0 sc1
  buffer_load_dwordx4 v[36:39], v5, s[60:63], s101 offen offset:1024 sc1
  s_add_u32 s101, s73, 143488
  buffer_load_dwordx4 v[40:43], v5, s[60:63], s101 offen offset:0 sc1
  buffer_load_dwordx4 v[44:47], v5, s[60:63], s101 offen offset:1024 sc1
  v_rcp_f32 v189, v189
  v_rcp_f32 v190, v190
  v_mfma_f32_32x32x16_bf16 v[144:159], a[28:31], v[108:111], v[144:159]
  ds_read_b64_tr_b16 a[12:13], v4 offset:24576
  ds_read_b64_tr_b16 a[14:15], v4 offset:25088
  v_rcp_f32 v191, v191
  v_mul_f32 v140, v140, v188
  v_mul_f32 v141, v141, v189
  v_mul_f32 v142, v142, v190
  v_mul_f32 v143, v143, v191
  ds_write_b32 v12, v184
  s_waitcnt lgkmcnt(0)
  s_barrier
  v_mfma_f32_32x32x16_bf16 v[144:159], a[0:3], v[112:115], v[144:159]
  v_mfma_f32_16x16x32_bf16 v[184:187], v[176:179], a[0:3], 0
  s_add_u32 s101, s74, 0
  buffer_load_dwordx4 v[48:51], v5, s[60:63], s101 offen offset:0 sc1
  buffer_load_dwordx4 v[52:55], v5, s[60:63], s101 offen offset:1024 sc1
  s_add_u32 s101, s74, 143488
  buffer_load_dwordx4 v[56:59], v5, s[60:63], s101 offen offset:0 sc1
  buffer_load_dwordx4 v[60:63], v5, s[60:63], s101 offen offset:1024 sc1
  v_mfma_f32_32x32x16_bf16 v[144:159], a[4:7], v[116:119], v[144:159]
  v_mfma_f32_16x16x32_bf16 v[184:187], v[176:179], a[4:7], v[184:187]
  v_mfma_f32_32x32x16_bf16 v[144:159], a[8:11], v[120:123], v[144:159]
  v_mfma_f32_16x16x32_bf16 v[184:187], v[176:179], a[8:11], v[184:187]
  ds_read_b128 v[188:191], v11
  s_add_u32 s101, s75, 0
  buffer_load_dwordx4 v[64:67], v5, s[60:63], s101 offen offset:0 sc1
  buffer_load_dwordx4 v[68:71], v5, s[60:63], s101 offen offset:1024 sc1
  s_add_u32 s101, s75, 143488
  buffer_load_dwordx4 v[72:75], v5, s[60:63], s101 offen offset:0 sc1
  buffer_load_dwordx4 v[76:79], v5, s[60:63], s101 offen offset:1024 sc1
  v_mfma_f32_32x32x16_bf16 v[144:159], a[12:15], v[124:127], v[144:159]
  v_mfma_f32_16x16x32_bf16 v[184:187], v[176:179], a[12:15], v[184:187]
  s_waitcnt lgkmcnt(0)
  v_add_f32 v188, v188, v189
  v_add_f32 v190, v190, v191
  s_nop 4
  v_add_f32 v188, v188, v184
  v_add_f32 v188, v188, v190
  v_and_b32 v189, 0xffff0000, v188
  v_sub_f32 v188, v188, v189
  v_cvt_pk_bf16_f32 v182, v189, v188
  s_nop 1
  v_mfma_f32_32x32x8_bf16 v[144:159], v[182:183], v[180:181], v[144:159]
  s_lshl_b32 s13, s8, 3
  s_add_u32 s13, s13, s57
  s_mul_i32 s13, s13, 7168
  s_lshl_b32 s11, s9, 7
  s_add_u32 s11, s11, s13
  v_lshrrev_b32 v205, 3, v0
  v_and_b32 v206, 7, v0
  v_mul_u32_u24 v1, 896, v205
  v_lshl_add_u32 v1, v206, 4, v1
  s_nop 2
  v_mul_f32 v144, v144, v128
  v_mul_f32 v145, v145, v129
  v_mul_f32 v146, v146, v130
  v_mul_f32 v147, v147, v131
  v_mul_f32 v152, v152, v136
  v_mul_f32 v153, v153, v137
  v_mul_f32 v154, v154, v138
  v_mul_f32 v155, v155, v139
  v_cvt_pk_bf16_f32 v144, v144, v145
  v_cvt_pk_bf16_f32 v145, v146, v147
  v_cvt_pk_bf16_f32 v146, v152, v153
  v_cvt_pk_bf16_f32 v147, v154, v155
  buffer_store_dwordx4 v[144:147], v5, s[60:63], s12 offen offset:0 sc1
  v_mul_f32 v148, v148, v132
  v_mul_f32 v149, v149, v133
  v_mul_f32 v150, v150, v134
  v_mul_f32 v151, v151, v135
  v_mul_f32 v156, v156, v140
  v_mul_f32 v157, v157, v141
  v_mul_f32 v158, v158, v142
  v_mul_f32 v159, v159, v143
  v_cvt_pk_bf16_f32 v148, v148, v149
  v_cvt_pk_bf16_f32 v149, v150, v151
  v_cvt_pk_bf16_f32 v150, v156, v157
  v_cvt_pk_bf16_f32 v151, v158, v159
  buffer_store_dwordx4 v[148:151], v5, s[60:63], s12 offen offset:1024 sc1
  buffer_load_dwordx4 a[32:35], v1, s[36:39], s11 offen
  s_waitcnt vmcnt(19)
  s_barrier
  ds_read_b64_tr_b16 a[0:1], v200 offset:0
  ds_read_b64_tr_b16 a[2:3], v200 offset:2048
  ds_read_b64_tr_b16 a[4:5], v201 offset:0
  ds_read_b64_tr_b16 a[6:7], v201 offset:2048
  ds_read_b64_tr_b16 a[8:9], v200 offset:1024
  ds_read_b64_tr_b16 a[10:11], v200 offset:3072
  ds_read_b64_tr_b16 a[12:13], v201 offset:1024
  ds_read_b64_tr_b16 a[14:15], v201 offset:3072
  s_waitcnt vmcnt(15) lgkmcnt(0)
  v_mfma_f32_32x32x16_bf16 v[128:143], a[0:3], v[16:19], 0
  v_mfma_f32_32x32x16_bf16 v[144:159], a[4:7], v[16:19], 0
  v_mfma_f32_32x32x16_bf16 v[160:175], a[0:3], v[24:27], 0
  v_mfma_f32_32x32x16_bf16 v[176:191], a[4:7], v[24:27], 0
  v_mfma_f32_32x32x16_bf16 v[128:143], a[8:11], v[20:23], v[128:143]
  ds_read_b64_tr_b16 a[16:17], v200 offset:16384
  ds_read_b64_tr_b16 a[18:19], v200 offset:18432
  v_mfma_f32_32x32x16_bf16 v[144:159], a[12:15], v[20:23], v[144:159]
  ds_read_b64_tr_b16 a[20:21], v201 offset:16384
  ds_read_b64_tr_b16 a[22:23], v201 offset:18432
  s_barrier
  s_add_u32 m0, s58, 65536
  s_add_u32 s100, s95, s83
  buffer_load_dwordx4 v196, s[52:55], s100 offen offset:0 lds
  buffer_load_dwordx4 v197, s[52:55], s100 offen offset:1024 lds
  buffer_load_dwordx4 v198, s[52:55], s100 offen offset:2048 lds
  buffer_load_dwordx4 v199, s[52:55], s100 offen offset:3072 lds
  s_add_u32 m0, s58, 81920
  s_add_u32 s100, s95, s84
  buffer_load_dwordx4 v196, s[52:55], s100 offen offset:0 lds
  buffer_load_dwordx4 v197, s[52:55], s100 offen offset:1024 lds
  buffer_load_dwordx4 v198, s[52:55], s100 offen offset:2048 lds
  buffer_load_dwordx4 v199, s[52:55], s100 offen offset:3072 lds
  v_mfma_f32_32x32x16_bf16 v[160:175], a[8:11], v[28:31], v[160:175]
  ds_read_b64_tr_b16 a[24:25], v200 offset:17408
  ds_read_b64_tr_b16 a[26:27], v200 offset:19456
  v_mfma_f32_32x32x16_bf16 v[176:191], a[12:15], v[28:31], v[176:191]
  ds_read_b64_tr_b16 a[28:29], v201 offset:17408
  ds_read_b64_tr_b16 a[30:31], v201 offset:19456
  s_waitcnt vmcnt(19) lgkmcnt(0)
  v_mfma_f32_32x32x16_bf16 v[128:143], a[16:19], v[32:35], v[128:143]
  v_mfma_f32_32x32x16_bf16 v[144:159], a[20:23], v[32:35], v[144:159]
  v_mfma_f32_32x32x16_bf16 v[160:175], a[16:19], v[40:43], v[160:175]
  v_mfma_f32_32x32x16_bf16 v[176:191], a[20:23], v[40:43], v[176:191]
  v_mfma_f32_32x32x16_bf16 v[128:143], a[24:27], v[36:39], v[128:143]
  ds_read_b64_tr_b16 a[0:1], v200 offset:32768
  ds_read_b64_tr_b16 a[2:3], v200 offset:34816
  v_mfma_f32_32x32x16_bf16 v[144:159], a[28:31], v[36:39], v[144:159]
  ds_read_b64_tr_b16 a[4:5], v201 offset:32768
  ds_read_b64_tr_b16 a[6:7], v201 offset:34816
  v_mfma_f32_32x32x16_bf16 v[160:175], a[24:27], v[44:47], v[160:175]
  ds_read_b64_tr_b16 a[8:9], v200 offset:33792
  ds_read_b64_tr_b16 a[10:11], v200 offset:35840
  v_mfma_f32_32x32x16_bf16 v[176:191], a[28:31], v[44:47], v[176:191]
  ds_read_b64_tr_b16 a[12:13], v201 offset:33792
  ds_read_b64_tr_b16 a[14:15], v201 offset:35840
  s_waitcnt vmcnt(9)
  s_mov_b64 exec, 1
  buffer_store_dwordx2 v[14:15], off, s[60:63], s14 offset:2048 sc1
  s_mov_b64 exec, -1
  s_barrier
  s_add_u32 s101, s76, 0
  buffer_load_dwordx4 v[80:83], v5, s[60:63], s101 offen offset:0 sc1
  buffer_load_dwordx4 v[84:87], v5, s[60:63], s101 offen offset:1024 sc1
  s_add_u32 s101, s76, 143488
  buffer_load_dwordx4 v[88:91], v5, s[60:63], s101 offen offset:0 sc1
  buffer_load_dwordx4 v[92:95], v5, s[60:63], s101 offen offset:1024 sc1
  s_add_u32 s101, s77, 0
  buffer_load_dwordx4 v[96:99], v5, s[60:63], s101 offen offset:0 sc1
  buffer_load_dwordx4 v[100:103], v5, s[60:63], s101 offen offset:1024 sc1
  s_add_u32 s101, s77, 143488
  buffer_load_dwordx4 v[104:107], v5, s[60:63], s101 offen offset:0 sc1
  buffer_load_dwordx4 v[108:111], v5, s[60:63], s101 offen offset:1024 sc1
  s_add_u32 s101, s78, 0
  buffer_load_dwordx4 v[112:115], v5, s[60:63], s101 offen offset:0 sc1
  buffer_load_dwordx4 v[116:119], v5, s[60:63], s101 offen offset:1024 sc1
  s_add_u32 s101, s78, 143488
  buffer_load_dwordx4 v[120:123], v5, s[60:63], s101 offen offset:0 sc1
  buffer_load_dwordx4 v[124:127], v5, s[60:63], s101 offen offset:1024 sc1
  s_add_u32 m0, s58, 98304
  s_add_u32 s100, s95, s85
  buffer_load_dwordx4 v196, s[52:55], s100 offen offset:0 lds
  buffer_load_dwordx4 v197, s[52:55], s100 offen offset:1024 lds
  buffer_load_dwordx4 v198, s[52:55], s100 offen offset:2048 lds
  buffer_load_dwordx4 v199, s[52:55], s100 offen offset:3072 lds
  s_add_u32 m0, s58, 114688
  s_add_u32 s100, s96, s79
  buffer_load_dwordx4 v196, s[52:55], s100 offen offset:0 lds
  buffer_load_dwordx4 v197, s[52:55], s100 offen offset:1024 lds
  buffer_load_dwordx4 v198, s[52:55], s100 offen offset:2048 lds
  buffer_load_dwordx4 v199, s[52:55], s100 offen offset:3072 lds
  s_add_u32 m0, s58, 0
  s_add_u32 s100, s96, s80
  buffer_load_dwordx4 v196, s[52:55], s100 offen offset:0 lds
  buffer_load_dwordx4 v197, s[52:55], s100 offen offset:1024 lds
  buffer_load_dwordx4 v198, s[52:55], s100 offen offset:2048 lds
  buffer_load_dwordx4 v199, s[52:55], s100 offen offset:3072 lds
  s_add_u32 m0, s58, 16384
  s_add_u32 s100, s96, s81
  buffer_load_dwordx4 v196, s[52:55], s100 offen offset:0 lds
  buffer_load_dwordx4 v197, s[52:55], s100 offen offset:1024 lds
  buffer_load_dwordx4 v198, s[52:55], s100 offen offset:2048 lds
  buffer_load_dwordx4 v199, s[52:55], s100 offen offset:3072 lds
  s_waitcnt lgkmcnt(0)
  v_mfma_f32_32x32x16_bf16 v[128:143], a[0:3], v[48:51], v[128:143]
  s_add_u32 m0, s58, 32768
  s_add_u32 s100, s96, s82
  buffer_load_dwordx4 v196, s[52:55], s100 offen offset:0 lds
  v_mfma_f32_32x32x16_bf16 v[144:159], a[4:7], v[48:51], v[144:159]
  buffer_load_dwordx4 v197, s[52:55], s100 offen offset:1024 lds
  v_mfma_f32_32x32x16_bf16 v[160:175], a[0:3], v[56:59], v[160:175]
  buffer_load_dwordx4 v198, s[52:55], s100 offen offset:2048 lds
  v_mfma_f32_32x32x16_bf16 v[176:191], a[4:7], v[56:59], v[176:191]
  buffer_load_dwordx4 v199, s[52:55], s100 offen offset:3072 lds
  v_mfma_f32_32x32x16_bf16 v[128:143], a[8:11], v[52:55], v[128:143]
  ds_read_b64_tr_b16 a[16:17], v200 offset:49152
  ds_read_b64_tr_b16 a[18:19], v200 offset:51200
  v_mfma_f32_32x32x16_bf16 v[144:159], a[12:15], v[52:55], v[144:159]
  ds_read_b64_tr_b16 a[20:21], v201 offset:49152
  ds_read_b64_tr_b16 a[22:23], v201 offset:51200
  v_mfma_f32_32x32x16_bf16 v[160:175], a[8:11], v[60:63], v[160:175]
  ds_read_b64_tr_b16 a[24:25], v200 offset:50176
  ds_read_b64_tr_b16 a[26:27], v200 offset:52224
  v_mfma_f32_32x32x16_bf16 v[176:191], a[12:15], v[60:63], v[176:191]
  ds_read_b64_tr_b16 a[28:29], v201 offset:50176
  ds_read_b64_tr_b16 a[30:31], v201 offset:52224
  s_waitcnt lgkmcnt(0)
  v_mfma_f32_32x32x16_bf16 v[128:143], a[16:19], v[64:67], v[128:143]
  s_add_u32 m0, s58, 49152
  s_add_u32 s100, s96, s83
  buffer_load_dwordx4 v196, s[52:55], s100 offen offset:0 lds
  buffer_load_dwordx2 v[6:7], v13, s[60:63], s10 offen offset:2048 sc1
  v_mfma_f32_32x32x16_bf16 v[144:159], a[20:23], v[64:67], v[144:159]
  buffer_load_dwordx4 v197, s[52:55], s100 offen offset:1024 lds
  v_mfma_f32_32x32x16_bf16 v[160:175], a[16:19], v[72:75], v[160:175]
  buffer_load_dwordx4 v198, s[52:55], s100 offen offset:2048 lds
  v_mfma_f32_32x32x16_bf16 v[176:191], a[20:23], v[72:75], v[176:191]
  buffer_load_dwordx4 v199, s[52:55], s100 offen offset:3072 lds
  v_mfma_f32_32x32x16_bf16 v[128:143], a[24:27], v[68:71], v[128:143]
  s_waitcnt vmcnt(42)
  v_add_u32 v200, 65536, v200
  ds_read_b64_tr_b16 a[0:1], v200 offset:0
  ds_read_b64_tr_b16 a[2:3], v200 offset:2048
  v_mfma_f32_32x32x16_bf16 v[144:159], a[28:31], v[68:71], v[144:159]
  v_add_u32 v201, 65536, v201
  ds_read_b64_tr_b16 a[4:5], v201 offset:0
  ds_read_b64_tr_b16 a[6:7], v201 offset:2048
  v_mfma_f32_32x32x16_bf16 v[160:175], a[24:27], v[76:79], v[160:175]
  ds_read_b64_tr_b16 a[8:9], v200 offset:1024
  ds_read_b64_tr_b16 a[10:11], v200 offset:3072
  v_mfma_f32_32x32x16_bf16 v[176:191], a[28:31], v[76:79], v[176:191]
  ds_read_b64_tr_b16 a[12:13], v201 offset:1024
  ds_read_b64_tr_b16 a[14:15], v201 offset:3072
  s_waitcnt vmcnt(33) lgkmcnt(0)
  v_mfma_f32_32x32x16_bf16 v[128:143], a[0:3], v[80:83], v[128:143]
  s_add_u32 m0, s58, 65536
  s_add_u32 s100, s96, s84
  buffer_load_dwordx4 v196, s[52:55], s100 offen offset:0 lds
  v_mfma_f32_32x32x16_bf16 v[144:159], a[4:7], v[80:83], v[144:159]
  buffer_load_dwordx4 v197, s[52:55], s100 offen offset:1024 lds
  v_mfma_f32_32x32x16_bf16 v[160:175], a[0:3], v[88:91], v[160:175]
  buffer_load_dwordx4 v198, s[52:55], s100 offen offset:2048 lds
  v_mfma_f32_32x32x16_bf16 v[176:191], a[4:7], v[88:91], v[176:191]
  buffer_load_dwordx4 v199, s[52:55], s100 offen offset:3072 lds
  v_mfma_f32_32x32x16_bf16 v[128:143], a[8:11], v[84:87], v[128:143]
  ds_read_b64_tr_b16 a[16:17], v200 offset:16384
  ds_read_b64_tr_b16 a[18:19], v200 offset:18432
  v_mfma_f32_32x32x16_bf16 v[144:159], a[12:15], v[84:87], v[144:159]
  ds_read_b64_tr_b16 a[20:21], v201 offset:16384
  ds_read_b64_tr_b16 a[22:23], v201 offset:18432
  v_mfma_f32_32x32x16_bf16 v[160:175], a[8:11], v[92:95], v[160:175]
  ds_read_b64_tr_b16 a[24:25], v200 offset:17408
  ds_read_b64_tr_b16 a[26:27], v200 offset:19456
  v_mfma_f32_32x32x16_bf16 v[176:191], a[12:15], v[92:95], v[176:191]
  ds_read_b64_tr_b16 a[28:29], v201 offset:17408
  ds_read_b64_tr_b16 a[30:31], v201 offset:19456
  s_waitcnt vmcnt(7)
  v_cmp_ne_u64 vcc, v[6:7], v[14:15]
  s_cbranch_vccnz SLOW5
BACK5:
  s_add_u32 s101, s72, 4096
  buffer_load_dwordx4 v[16:19], v5, s[60:63], s101 offen offset:0 sc1
  buffer_load_dwordx4 v[20:23], v5, s[60:63], s101 offen offset:1024 sc1
  s_add_u32 s101, s72, 147584
  buffer_load_dwordx4 v[24:27], v5, s[60:63], s101 offen offset:0 sc1
  buffer_load_dwordx4 v[28:31], v5, s[60:63], s101 offen offset:1024 sc1
  s_add_u32 s101, s73, 4096
  buffer_load_dwordx4 v[32:35], v5, s[60:63], s101 offen offset:0 sc1
  buffer_load_dwordx4 v[36:39], v5, s[60:63], s101 offen offset:1024 sc1
  s_add_u32 s101, s73, 147584
  buffer_load_dwordx4 v[40:43], v5, s[60:63], s101 offen offset:0 sc1
  buffer_load_dwordx4 v[44:47], v5, s[60:63], s101 offen offset:1024 sc1
  s_add_u32 s101, s74, 4096
  buffer_load_dwordx4 v[48:51], v5, s[60:63], s101 offen offset:0 sc1
  buffer_load_dwordx4 v[52:55], v5, s[60:63], s101 offen offset:1024 sc1
  s_add_u32 s101, s74, 147584
  buffer_load_dwordx4 v[56:59], v5, s[60:63], s101 offen offset:0 sc1
  buffer_load_dwordx4 v[60:63], v5, s[60:63], s101 offen offset:1024 sc1
  s_add_u32 s101, s75, 4096
  buffer_load_dwordx4 v[64:67], v5, s[60:63], s101 offen offset:0 sc1
  buffer_load_dwordx4 v[68:71], v5, s[60:63], s101 offen offset:1024 sc1
  s_add_u32 s101, s75, 147584
  buffer_load_dwordx4 v[72:75], v5, s[60:63], s101 offen offset:0 sc1
  buffer_load_dwordx4 v[76:79], v5, s[60:63], s101 offen offset:1024 sc1
  s_add_u32 s101, s76, 4096
  buffer_load_dwordx4 v[80:83], v5, s[60:63], s101 offen offset:0 sc1
  buffer_load_dwordx4 v[84:87], v5, s[60:63], s101 offen offset:1024 sc1
  s_add_u32 s101, s76, 147584
  buffer_load_dwordx4 v[88:91], v5, s[60:63], s101 offen offset:0 sc1
  buffer_load_dwordx4 v[92:95], v5, s[60:63], s101 offen offset:1024 sc1
  s_waitcnt lgkmcnt(0)
  v_mfma_f32_32x32x16_bf16 v[128:143], a[16:19], v[96:99], v[128:143]
  s_add_u32 m0, s58, 81920
  s_add_u32 s100, s96, s85
  buffer_load_dwordx4 v196, s[52:55], s100 offen offset:0 lds
  v_mfma_f32_32x32x16_bf16 v[144:159], a[20:23], v[96:99], v[144:159]
  buffer_load_dwordx4 v197, s[52:55], s100 offen offset:1024 lds
  v_mfma_f32_32x32x16_bf16 v[160:175], a[16:19], v[104:107], v[160:175]
  buffer_load_dwordx4 v198, s[52:55], s100 offen offset:2048 lds
  v_mfma_f32_32x32x16_bf16 v[176:191], a[20:23], v[104:107], v[176:191]
  buffer_load_dwordx4 v199, s[52:55], s100 offen offset:3072 lds
  v_mfma_f32_32x32x16_bf16 v[128:143], a[24:27], v[100:103], v[128:143]
  ds_read_b64_tr_b16 a[0:1], v200 offset:32768
  ds_read_b64_tr_b16 a[2:3], v200 offset:34816
  v_mfma_f32_32x32x16_bf16 v[144:159], a[28:31], v[100:103], v[144:159]
  ds_read_b64_tr_b16 a[4:5], v201 offset:32768
  ds_read_b64_tr_b16 a[6:7], v201 offset:34816
  v_mfma_f32_32x32x16_bf16 v[160:175], a[24:27], v[108:111], v[160:175]
  ds_read_b64_tr_b16 a[8:9], v200 offset:33792
  ds_read_b64_tr_b16 a[10:11], v200 offset:35840
  v_mfma_f32_32x32x16_bf16 v[176:191], a[28:31], v[108:111], v[176:191]
  ds_read_b64_tr_b16 a[12:13], v201 offset:33792
  ds_read_b64_tr_b16 a[14:15], v201 offset:35840
  s_add_u32 s101, s77, 4096
  buffer_load_dwordx4 v[96:99], v5, s[60:63], s101 offen offset:0 sc1
  buffer_load_dwordx4 v[100:103], v5, s[60:63], s101 offen offset:1024 sc1
  s_add_u32 s101, s77, 147584
  buffer_load_dwordx4 v[104:107], v5, s[60:63], s101 offen offset:0 sc1
  buffer_load_dwordx4 v[108:111], v5, s[60:63], s101 offen offset:1024 sc1
  s_waitcnt lgkmcnt(0)
  v_mfma_f32_32x32x16_bf16 v[128:143], a[0:3], v[112:115], v[128:143]
  v_mfma_f32_32x32x16_bf16 v[144:159], a[4:7], v[112:115], v[144:159]
  v_mfma_f32_32x32x16_bf16 v[160:175], a[0:3], v[120:123], v[160:175]
  v_mfma_f32_32x32x16_bf16 v[176:191], a[4:7], v[120:123], v[176:191]
  v_mfma_f32_32x32x16_bf16 v[128:143], a[8:11], v[116:119], v[128:143]
  ds_read_b64_tr_b16 a[16:17], v200 offset:49152
  ds_read_b64_tr_b16 a[18:19], v200 offset:51200
  v_mfma_f32_32x32x16_bf16 v[144:159], a[12:15], v[116:119], v[144:159]
  ds_read_b64_tr_b16 a[20:21], v201 offset:49152
  ds_read_b64_tr_b16 a[22:23], v201 offset:51200
  v_mfma_f32_32x32x16_bf16 v[160:175], a[8:11], v[124:127], v[160:175]
  ds_read_b64_tr_b16 a[24:25], v200 offset:50176
  ds_read_b64_tr_b16 a[26:27], v200 offset:52224
  v_mfma_f32_32x32x16_bf16 v[176:191], a[12:15], v[124:127], v[176:191]
  ds_read_b64_tr_b16 a[28:29], v201 offset:50176
  ds_read_b64_tr_b16 a[30:31], v201 offset:52224
  s_add_u32 s101, s78, 4096
  buffer_load_dwordx4 v[112:115], v5, s[60:63], s101 offen offset:0 sc1
  buffer_load_dwordx4 v[116:119], v5, s[60:63], s101 offen offset:1024 sc1
  s_add_u32 s101, s78, 147584
  buffer_load_dwordx4 v[120:123], v5, s[60:63], s101 offen offset:0 sc1
  buffer_load_dwordx4 v[124:127], v5, s[60:63], s101 offen offset:1024 sc1
  s_waitcnt vmcnt(28) lgkmcnt(0)
  v_mfma_f32_32x32x16_bf16 v[128:143], a[16:19], v[16:19], v[128:143]
  v_mfma_f32_32x32x16_bf16 v[144:159], a[20:23], v[16:19], v[144:159]
  v_mfma_f32_32x32x16_bf16 v[160:175], a[16:19], v[24:27], v[160:175]
  v_mfma_f32_32x32x16_bf16 v[176:191], a[20:23], v[24:27], v[176:191]
  v_mfma_f32_32x32x16_bf16 v[128:143], a[24:27], v[20:23], v[128:143]
  v_add_u32 v200, 4294901760, v200
  ds_read_b64_tr_b16 a[0:1], v200 offset:0
  ds_read_b64_tr_b16 a[2:3], v200 offset:2048
  v_mfma_f32_32x32x16_bf16 v[144:159], a[28:31], v[20:23], v[144:159]
  v_add_u32 v201, 4294901760, v201
  ds_read_b64_tr_b16 a[4:5], v201 offset:0
  ds_read_b64_tr_b16 a[6:7], v201 offset:2048
  v_mfma_f32_32x32x16_bf16 v[160:175], a[24:27], v[28:31], v[160:175]
  ds_read_b64_tr_b16 a[8:9], v200 offset:1024
  ds_read_b64_tr_b16 a[10:11], v200 offset:3072
  v_mfma_f32_32x32x16_bf16 v[176:191], a[28:31], v[28:31], v[176:191]
  ds_read_b64_tr_b16 a[12:13], v201 offset:1024
  ds_read_b64_tr_b16 a[14:15], v201 offset:3072
  s_waitcnt vmcnt(24) lgkmcnt(0)
  v_mfma_f32_32x32x16_bf16 v[128:143], a[0:3], v[32:35], v[128:143]
  v_mfma_f32_32x32x16_bf16 v[144:159], a[4:7], v[32:35], v[144:159]
  v_mfma_f32_32x32x16_bf16 v[160:175], a[0:3], v[40:43], v[160:175]
  v_mfma_f32_32x32x16_bf16 v[176:191], a[4:7], v[40:43], v[176:191]
  v_mfma_f32_32x32x16_bf16 v[128:143], a[8:11], v[36:39], v[128:143]
  ds_read_b64_tr_b16 a[16:17], v200 offset:16384
  ds_read_b64_tr_b16 a[18:19], v200 offset:18432
  v_mfma_f32_32x32x16_bf16 v[144:159], a[12:15], v[36:39], v[144:159]
  ds_read_b64_tr_b16 a[20:21], v201 offset:16384
  ds_read_b64_tr_b16 a[22:23], v201 offset:18432
  v_mfma_f32_32x32x16_bf16 v[160:175], a[8:11], v[44:47], v[160:175]
  ds_read_b64_tr_b16 a[24:25], v200 offset:17408
  ds_read_b64_tr_b16 a[26:27], v200 offset:19456
  v_mfma_f32_32x32x16_bf16 v[176:191], a[12:15], v[44:47], v[176:191]
  ds_read_b64_tr_b16 a[28:29], v201 offset:17408
  ds_read_b64_tr_b16 a[30:31], v201 offset:19456
  s_waitcnt vmcnt(20) lgkmcnt(0)
  v_mfma_f32_32x32x16_bf16 v[128:143], a[16:19], v[48:51], v[128:143]
  v_mfma_f32_32x32x16_bf16 v[144:159], a[20:23], v[48:51], v[144:159]
  v_mfma_f32_32x32x16_bf16 v[160:175], a[16:19], v[56:59], v[160:175]
  v_mfma_f32_32x32x16_bf16 v[176:191], a[20:23], v[56:59], v[176:191]
  v_mfma_f32_32x32x16_bf16 v[128:143], a[24:27], v[52:55], v[128:143]
  ds_read_b64_tr_b16 a[0:1], v200 offset:32768
  ds_read_b64_tr_b16 a[2:3], v200 offset:34816
  v_mfma_f32_32x32x16_bf16 v[144:159], a[28:31], v[52:55], v[144:159]
  ds_read_b64_tr_b16 a[4:5], v201 offset:32768
  ds_read_b64_tr_b16 a[6:7], v201 offset:34816
  v_mfma_f32_32x32x16_bf16 v[160:175], a[24:27], v[60:63], v[160:175]
  ds_read_b64_tr_b16 a[8:9], v200 offset:33792
  ds_read_b64_tr_b16 a[10:11], v200 offset:35840
  v_mfma_f32_32x32x16_bf16 v[176:191], a[28:31], v[60:63], v[176:191]
  ds_read_b64_tr_b16 a[12:13], v201 offset:33792
  ds_read_b64_tr_b16 a[14:15], v201 offset:35840
  s_waitcnt vmcnt(16) lgkmcnt(0)
  v_mfma_f32_32x32x16_bf16 v[128:143], a[0:3], v[64:67], v[128:143]
  v_mfma_f32_32x32x16_bf16 v[144:159], a[4:7], v[64:67], v[144:159]
  v_and_b32 v205, 31, v0
  v_lshrrev_b32 v206, 5, v0
  v_bfe_u32 v207, v0, 1, 2
  v_xor_b32 v206, v206, v207
  v_and_b32 v207, 1, v0
  v_lshlrev_b32 v207, 2, v207
  v_xor_b32 v206, v206, v207
  v_lshlrev_b32 v206, 4, v206
  v_lshl_add_u32 v205, v205, 7, v206
  v_add_u32 v8, s58, v205
  v_xor_b32 v9, 32, v8
  v_xor_b32 v10, 64, v8
  v_xor_b32 v11, 96, v8
  v_mfma_f32_32x32x16_bf16 v[160:175], a[0:3], v[72:75], v[160:175]
  v_mfma_f32_32x32x16_bf16 v[176:191], a[4:7], v[72:75], v[176:191]
  v_mfma_f32_32x32x16_bf16 v[128:143], a[8:11], v[68:71], v[128:143]
  ds_read_b64_tr_b16 a[16:17], v200 offset:49152
  ds_read_b64_tr_b16 a[18:19], v200 offset:51200
  v_mfma_f32_32x32x16_bf16 v[144:159], a[12:15], v[68:71], v[144:159]
  ds_read_b64_tr_b16 a[20:21], v201 offset:49152
  ds_read_b64_tr_b16 a[22:23], v201 offset:51200
  v_mfma_f32_32x32x16_bf16 v[160:175], a[8:11], v[76:79], v[160:175]
  ds_read_b64_tr_b16 a[24:25], v200 offset:50176
  ds_read_b64_tr_b16 a[26:27], v200 offset:52224
  v_mfma_f32_32x32x16_bf16 v[176:191], a[12:15], v[76:79], v[176:191]
  ds_read_b64_tr_b16 a[28:29], v201 offset:50176
  ds_read_b64_tr_b16 a[30:31], v201 offset:52224
  s_waitcnt vmcnt(12) lgkmcnt(0)
  v_mfma_f32_32x32x16_bf16 v[128:143], a[16:19], v[80:83], v[128:143]
  v_mfma_f32_32x32x16_bf16 v[144:159], a[20:23], v[80:83], v[144:159]
  v_mfma_f32_32x32x16_bf16 v[160:175], a[16:19], v[88:91], v[160:175]
  v_mfma_f32_32x32x16_bf16 v[176:191], a[20:23], v[88:91], v[176:191]
  v_mfma_f32_32x32x16_bf16 v[128:143], a[24:27], v[84:87], v[128:143]
  v_add_u32 v200, 65536, v200
  ds_read_b64_tr_b16 a[0:1], v200 offset:0
  ds_read_b64_tr_b16 a[2:3], v200 offset:2048
  v_mfma_f32_32x32x16_bf16 v[144:159], a[28:31], v[84:87], v[144:159]
  v_add_u32 v201, 65536, v201
  ds_read_b64_tr_b16 a[4:5], v201 offset:0
  ds_read_b64_tr_b16 a[6:7], v201 offset:2048
  v_mfma_f32_32x32x16_bf16 v[160:175], a[24:27], v[92:95], v[160:175]
  ds_read_b64_tr_b16 a[8:9], v200 offset:1024
  ds_read_b64_tr_b16 a[10:11], v200 offset:3072
  v_mfma_f32_32x32x16_bf16 v[176:191], a[28:31], v[92:95], v[176:191]
  ds_read_b64_tr_b16 a[12:13], v201 offset:1024
  ds_read_b64_tr_b16 a[14:15], v201 offset:3072
  s_waitcnt vmcnt(4) lgkmcnt(0)
  v_mfma_f32_32x32x16_bf16 v[128:143], a[0:3], v[96:99], v[128:143]
  v_mfma_f32_32x32x16_bf16 v[144:159], a[4:7], v[96:99], v[144:159]
  v_lshrrev_b32 v2, 3, v0
  v_and_b32 v3, 3, v0
  v_lshlrev_b32 v3, 1, v3
  v_lshrrev_b32 v4, 4, v0
  v_xor_b32 v3, v3, v4
  v_bfe_u32 v4, v0, 3, 1
  v_lshlrev_b32 v4, 2, v4
  v_xor_b32 v3, v3, v4
  v_lshlrev_b32 v3, 4, v3
  v_lshl_add_u32 v3, v2, 7, v3
  v_bfe_u32 v4, v0, 2, 1
  s_lshl_b32 s13, s4, 10
  s_lshl_b32 s100, s56, 15
  s_add_u32 s100, s100, s13
  s_lshl_b32 s101, s56, 14
  s_add_u32 s101, s101, s13
  s_add_u32 s101, s101, 131072
  v_lshl_add_u32 v192, v4, 14, v3
  v_lshl_add_u32 v194, v4, 13, v3
  v_add_u32 v192, s100, v192
  v_xor_b32 v193, 16, v192
  v_add_u32 v194, s101, v194
  v_xor_b32 v195, 16, v194
  v_accvgpr_read_b32 v204, a32
  v_accvgpr_read_b32 v205, a33
  v_accvgpr_read_b32 v206, a34
  v_accvgpr_read_b32 v207, a35
  v_mfma_f32_32x32x16_bf16 v[160:175], a[0:3], v[104:107], v[160:175]
  v_mfma_f32_32x32x16_bf16 v[176:191], a[4:7], v[104:107], v[176:191]
  v_mfma_f32_32x32x16_bf16 v[128:143], a[8:11], v[100:103], v[128:143]
  ds_read_b64_tr_b16 a[16:17], v200 offset:16384
  ds_read_b64_tr_b16 a[18:19], v200 offset:18432
  v_mfma_f32_32x32x16_bf16 v[144:159], a[12:15], v[100:103], v[144:159]
  ds_read_b64_tr_b16 a[20:21], v201 offset:16384
  ds_read_b64_tr_b16 a[22:23], v201 offset:18432
  v_mfma_f32_32x32x16_bf16 v[160:175], a[8:11], v[108:111], v[160:175]
  ds_read_b64_tr_b16 a[24:25], v200 offset:17408
  ds_read_b64_tr_b16 a[26:27], v200 offset:19456
  v_mfma_f32_32x32x16_bf16 v[176:191], a[12:15], v[108:111], v[176:191]
  ds_read_b64_tr_b16 a[28:29], v201 offset:17408
  ds_read_b64_tr_b16 a[30:31], v201 offset:19456
  s_waitcnt vmcnt(0) lgkmcnt(0)
  v_mfma_f32_32x32x16_bf16 v[128:143], a[16:19], v[112:115], v[128:143]
  v_mfma_f32_32x32x16_bf16 v[144:159], a[20:23], v[112:115], v[144:159]
  v_mfma_f32_32x32x16_bf16 v[128:143], a[24:27], v[116:119], v[128:143]
  v_mfma_f32_32x32x16_bf16 v[144:159], a[28:31], v[116:119], v[144:159]
  v_mfma_f32_32x32x16_bf16 v[160:175], a[16:19], v[120:123], v[160:175]
  v_mfma_f32_32x32x16_bf16 v[176:191], a[20:23], v[120:123], v[176:191]
  v_mfma_f32_32x32x16_bf16 v[160:175], a[24:27], v[124:127], v[160:175]
  s_nop 7
  ds_write_b128 v8, v[128:131] offset:0
  ds_write_b128 v9, v[132:135] offset:0
  ds_write_b128 v10, v[136:139] offset:0
  ds_write_b128 v11, v[140:143] offset:0
  v_mfma_f32_32x32x16_bf16 v[176:191], a[28:31], v[124:127], v[176:191]
  ds_write_b128 v8, v[144:147] offset:16384
  ds_write_b128 v9, v[148:151] offset:16384
  ds_write_b128 v10, v[152:155] offset:16384
  ds_write_b128 v11, v[156:159] offset:16384
  ds_write_b128 v8, v[160:163] offset:32768
  ds_write_b128 v9, v[164:167] offset:32768
  ds_write_b128 v10, v[168:171] offset:32768
  ds_write_b128 v11, v[172:175] offset:32768
  s_nop 3
  ds_write_b128 v8, v[176:179] offset:49152
  ds_write_b128 v9, v[180:183] offset:49152
  ds_write_b128 v10, v[184:187] offset:49152
  ds_write_b128 v11, v[188:191] offset:49152
  s_branch P2DONE
P2S:
  s_nop 11
  ds_write_b32 v12, v184
  s_waitcnt lgkmcnt(0)
  s_waitcnt vmcnt(6)
  s_barrier
  ds_read_b128 v[188:191], v11
  v_mfma_f32_32x32x16_bf16 v[144:159], a[0:3], v[16:19], 0
  ds_read_b64_tr_b16 a[16:17], v1 offset:57344
  ds_read_b64_tr_b16 a[18:19], v1 offset:57856
  v_mfma_f32_32x32x16_bf16 v[144:159], a[4:7], v[20:23], v[144:159]
  ds_read_b64_tr_b16 a[20:21], v2 offset:57344
  ds_read_b64_tr_b16 a[22:23], v2 offset:57856
  v_mfma_f32_16x16x32_bf16 v[184:187], v[176:179], a[0:3], 0
  s_waitcnt lgkmcnt(4)
  v_add_f32 v188, v188, v189
  v_add_f32 v190, v190, v191
  v_add_f32 v188, v188, v190
  v_and_b32 v189, 0xffff0000, v188
  v_sub_f32 v188, v188, v189
  v_cvt_pk_bf16_f32 v182, v189, v188
  s_nop 1
  v_mfma_f32_32x32x8_bf16 v[128:143], v[182:183], v[180:181], v[128:143]
  v_mfma_f32_32x32x16_bf16 v[144:159], a[8:11], v[24:27], v[144:159]
  ds_read_b64_tr_b16 a[24:25], v3 offset:57344
  ds_read_b64_tr_b16 a[26:27], v3 offset:57856
  s_add_u32 m0, s94, 32768
  s_add_u32 s100, s97, s81
  buffer_load_dwordx4 v196, s[52:55], s100 offen offset:0 lds
  v_mfma_f32_32x32x16_bf16 v[144:159], a[12:15], v[28:31], v[144:159]
  ds_read_b64_tr_b16 a[28:29], v4 offset:57344
  ds_read_b64_tr_b16 a[30:31], v4 offset:57856
  s_nop 2
  v_mul_f32 v192, v128, v8
  v_mul_f32 v193, v129, v8
  v_mul_f32 v194, v130, v8
  v_mul_f32 v195, v131, v8
  s_waitcnt lgkmcnt(4)
  v_mfma_f32_32x32x16_bf16 v[144:159], a[16:19], v[32:35], v[144:159]
  v_add_u32 v1, 4294901760, v1
  ds_read_b64_tr_b16 a[0:1], v1 offset:49152
  ds_read_b64_tr_b16 a[2:3], v1 offset:49664
  v_exp_f32 v192, v192
  v_exp_f32 v193, v193
  v_exp_f32 v194, v194
  v_mfma_f32_32x32x16_bf16 v[144:159], a[20:23], v[36:39], v[144:159]
  v_add_u32 v2, 4294901760, v2
  ds_read_b64_tr_b16 a[4:5], v2 offset:49152
  ds_read_b64_tr_b16 a[6:7], v2 offset:49664
  v_mfma_f32_16x16x32_bf16 v[184:187], v[176:179], a[16:19], v[184:187]
  v_exp_f32 v195, v195
  v_fma_f32 v192, v192, v9, v9
  v_fma_f32 v193, v193, v9, v9
  v_fma_f32 v194, v194, v9, v9
  s_waitcnt lgkmcnt(4)
  v_mfma_f32_32x32x16_bf16 v[144:159], a[24:27], v[40:43], v[144:159]
  v_add_u32 v3, 4294901760, v3
  ds_read_b64_tr_b16 a[8:9], v3 offset:49152
  ds_read_b64_tr_b16 a[10:11], v3 offset:49664
  s_add_u32 m0, s94, 32768
  s_add_u32 s100, s97, s81
  buffer_load_dwordx4 v197, s[52:55], s100 offen offset:1024 lds
  v_fma_f32 v195, v195, v9, v9
  v_rcp_f32 v192, v192
  v_rcp_f32 v193, v193
  v_mfma_f32_32x32x16_bf16 v[144:159], a[28:31], v[44:47], v[144:159]
  v_add_u32 v4, 4294901760, v4
  ds_read_b64_tr_b16 a[12:13], v4 offset:49152
  ds_read_b64_tr_b16 a[14:15], v4 offset:49664
  v_rcp_f32 v194, v194
  v_rcp_f32 v195, v195
  v_mul_f32 v128, v128, v192
  v_mul_f32 v129, v129, v193
  s_waitcnt vmcnt(6)
  s_barrier
  s_waitcnt lgkmcnt(4)
  v_mfma_f32_32x32x16_bf16 v[144:159], a[0:3], v[48:51], v[144:159]
  ds_read_b64_tr_b16 a[16:17], v1 offset:57344
  ds_read_b64_tr_b16 a[18:19], v1 offset:57856
  v_mul_f32 v130, v130, v194
  v_mul_f32 v131, v131, v195
  v_mul_f32 v188, v132, v8
  v_mul_f32 v189, v133, v8
  v_mul_f32 v190, v134, v8
  v_mfma_f32_32x32x16_bf16 v[144:159], a[4:7], v[52:55], v[144:159]
  ds_read_b64_tr_b16 a[20:21], v2 offset:57344
  ds_read_b64_tr_b16 a[22:23], v2 offset:57856
  v_mfma_f32_16x16x32_bf16 v[184:187], v[176:179], a[0:3], v[184:187]
  v_mul_f32 v191, v135, v8
  v_exp_f32 v188, v188
  v_exp_f32 v189, v189
  s_waitcnt lgkmcnt(4)
  v_mfma_f32_32x32x16_bf16 v[144:159], a[8:11], v[56:59], v[144:159]
  ds_read_b64_tr_b16 a[24:25], v3 offset:57344
  ds_read_b64_tr_b16 a[26:27], v3 offset:57856
  s_add_u32 m0, s94, 114688
  s_add_u32 s100, s7, 344064
  buffer_load_dwordx4 v196, s[40:43], s100 offen offset:0 lds
  v_exp_f32 v190, v190
  v_exp_f32 v191, v191
  v_fma_f32 v188, v188, v9, v9
  v_fma_f32 v189, v189, v9, v9
  v_mfma_f32_32x32x16_bf16 v[144:159], a[12:15], v[60:63], v[144:159]
  ds_read_b64_tr_b16 a[28:29], v4 offset:57344
  ds_read_b64_tr_b16 a[30:31], v4 offset:57856
  v_fma_f32 v190, v190, v9, v9
  v_fma_f32 v191, v191, v9, v9
  v_rcp_f32 v188, v188
  v_rcp_f32 v189, v189
  s_waitcnt lgkmcnt(4)
  v_mfma_f32_32x32x16_bf16 v[144:159], a[16:19], v[64:67], v[144:159]
  v_add_u32 v1, 131072, v1
  ds_read_b64_tr_b16 a[0:1], v1 offset:0
  ds_read_b64_tr_b16 a[2:3], v1 offset:512
  s_add_u32 m0, s94, 114688
  s_add_u32 s100, s7, 344064
  buffer_load_dwordx4 v197, s[40:43], s100 offen offset:1024 lds
  v_rcp_f32 v190, v190
  v_rcp_f32 v191, v191
  v_mul_f32 v132, v132, v188
  v_mfma_f32_32x32x16_bf16 v[144:159], a[20:23], v[68:71], v[144:159]
  v_add_u32 v2, 131072, v2
  ds_read_b64_tr_b16 a[4:5], v2 offset:0
  ds_read_b64_tr_b16 a[6:7], v2 offset:512
  v_mfma_f32_16x16x32_bf16 v[184:187], v[176:179], a[16:19], v[184:187]
  v_mul_f32 v133, v133, v189
  v_mul_f32 v134, v134, v190
  v_mul_f32 v135, v135, v191
  v_mul_f32 v192, v136, v8
  v_mul_f32 v193, v137, v8
  s_waitcnt lgkmcnt(4)
  v_mfma_f32_32x32x16_bf16 v[144:159], a[24:27], v[72:75], v[144:159]
  v_add_u32 v3, 131072, v3
  ds_read_b64_tr_b16 a[8:9], v3 offset:0
  ds_read_b64_tr_b16 a[10:11], v3 offset:512
  v_mul_f32 v194, v138, v8
  v_mul_f32 v195, v139, v8
  v_exp_f32 v192, v192
  v_exp_f32 v193, v193
  v_mfma_f32_32x32x16_bf16 v[144:159], a[28:31], v[76:79], v[144:159]
  v_add_u32 v4, 131072, v4
  ds_read_b64_tr_b16 a[12:13], v4 offset:0
  ds_read_b64_tr_b16 a[14:15], v4 offset:512
  v_exp_f32 v194, v194
  v_exp_f32 v195, v195
  v_fma_f32 v192, v192, v9, v9
  s_waitcnt vmcnt(5)
  s_barrier
  s_waitcnt lgkmcnt(4)
  v_mfma_f32_32x32x16_bf16 v[144:159], a[0:3], v[80:83], v[144:159]
  ds_read_b64_tr_b16 a[16:17], v1 offset:8192
  ds_read_b64_tr_b16 a[18:19], v1 offset:8704
  s_add_u32 m0, s94, 49152
  s_add_u32 s100, s97, s82
  buffer_load_dwordx4 v196, s[52:55], s100 offen offset:0 lds
  v_fma_f32 v193, v193, v9, v9
  v_fma_f32 v194, v194, v9, v9
  v_fma_f32 v195, v195, v9, v9
  v_rcp_f32 v192, v192
  v_mfma_f32_32x32x16_bf16 v[144:159], a[4:7], v[84:87], v[144:159]
  ds_read_b64_tr_b16 a[20:21], v2 offset:8192
  ds_read_b64_tr_b16 a[22:23], v2 offset:8704
  v_mfma_f32_16x16x32_bf16 v[184:187], v[176:179], a[0:3], v[184:187]
  v_rcp_f32 v193, v193
  v_rcp_f32 v194, v194
  v_rcp_f32 v195, v195
  s_waitcnt lgkmcnt(4)
  v_mfma_f32_32x32x16_bf16 v[144:159], a[8:11], v[88:91], v[144:159]
  ds_read_b64_tr_b16 a[24:25], v3 offset:8192
  ds_read_b64_tr_b16 a[26:27], v3 offset:8704
  s_add_u32 m0, s94, 49152
  s_add_u32 s100, s97, s82
  buffer_load_dwordx4 v197, s[52:55], s100 offen offset:1024 lds
  v_mul_f32 v136, v136, v192
  v_mul_f32 v137, v137, v193
  v_mul_f32 v138, v138, v194
  v_mul_f32 v139, v139, v195
  v_mul_f32 v188, v140, v8
  v_mfma_f32_32x32x16_bf16 v[144:159], a[12:15], v[92:95], v[144:159]
  ds_read_b64_tr_b16 a[28:29], v4 offset:8192
  ds_read_b64_tr_b16 a[30:31], v4 offset:8704
  v_mul_f32 v189, v141, v8
  v_mul_f32 v190, v142, v8
  v_mul_f32 v191, v143, v8
  v_exp_f32 v188, v188
  s_waitcnt lgkmcnt(4)
  v_mfma_f32_32x32x16_bf16 v[144:159], a[16:19], v[96:99], v[144:159]
  ds_read_b64_tr_b16 a[0:1], v1 offset:24576
  ds_read_b64_tr_b16 a[2:3], v1 offset:25088
  v_exp_f32 v189, v189
  v_exp_f32 v190, v190
  v_exp_f32 v191, v191
  v_mfma_f32_32x32x16_bf16 v[144:159], a[20:23], v[100:103], v[144:159]
  ds_read_b64_tr_b16 a[4:5], v2 offset:24576
  ds_read_b64_tr_b16 a[6:7], v2 offset:25088
  v_mfma_f32_16x16x32_bf16 v[184:187], v[176:179], a[16:19], v[184:187]
  v_fma_f32 v188, v188, v9, v9
  v_fma_f32 v189, v189, v9, v9
  v_fma_f32 v190, v190, v9, v9
  v_fma_f32 v191, v191, v9, v9
  v_rcp_f32 v188, v188
  s_waitcnt lgkmcnt(4)
  v_mfma_f32_32x32x16_bf16 v[144:159], a[24:27], v[104:107], v[144:159]
  ds_read_b64_tr_b16 a[8:9], v3 offset:24576
  ds_read_b64_tr_b16 a[10:11], v3 offset:25088
  v_rcp_f32 v189, v189
  v_rcp_f32 v190, v190
  v_mfma_f32_32x32x16_bf16 v[144:159], a[28:31], v[108:111], v[144:159]
  ds_read_b64_tr_b16 a[12:13], v4 offset:24576
  ds_read_b64_tr_b16 a[14:15], v4 offset:25088
  v_rcp_f32 v191, v191
  v_mul_f32 v140, v140, v188
  v_mul_f32 v141, v141, v189
  v_mul_f32 v142, v142, v190
  v_mul_f32 v143, v143, v191
  ds_write_b32 v12, v184
  s_waitcnt lgkmcnt(0)
  s_barrier
  v_mfma_f32_32x32x16_bf16 v[144:159], a[0:3], v[112:115], v[144:159]
  v_mfma_f32_16x16x32_bf16 v[184:187], v[176:179], a[0:3], 0
  v_mfma_f32_32x32x16_bf16 v[144:159], a[4:7], v[116:119], v[144:159]
  v_mfma_f32_16x16x32_bf16 v[184:187], v[176:179], a[4:7], v[184:187]
  v_mfma_f32_32x32x16_bf16 v[144:159], a[8:11], v[120:123], v[144:159]
  v_mfma_f32_16x16x32_bf16 v[184:187], v[176:179], a[8:11], v[184:187]
  ds_read_b128 v[188:191], v11
  v_mfma_f32_32x32x16_bf16 v[144:159], a[12:15], v[124:127], v[144:159]
  v_mfma_f32_16x16x32_bf16 v[184:187], v[176:179], a[12:15], v[184:187]
  s_waitcnt lgkmcnt(0)
  v_add_f32 v188, v188, v189
  v_add_f32 v190, v190, v191
  s_nop 4
  v_add_f32 v188, v188, v184
  v_add_f32 v188, v188, v190
  v_and_b32 v189, 0xffff0000, v188
  v_sub_f32 v188, v188, v189
  v_cvt_pk_bf16_f32 v182, v189, v188
  s_nop 1
  v_mfma_f32_32x32x8_bf16 v[144:159], v[182:183], v[180:181], v[144:159]
  s_lshl_b32 s13, s8, 3
  s_add_u32 s13, s13, s57
  s_mul_i32 s13, s13, 7168
  s_lshl_b32 s11, s9, 7
  s_add_u32 s11, s11, s13
  v_lshrrev_b32 v205, 3, v0
  v_and_b32 v206, 7, v0
  v_mul_u32_u24 v1, 896, v205
  v_lshl_add_u32 v1, v206, 4, v1
  s_nop 2
  v_mul_f32 v144, v144, v128
  v_mul_f32 v145, v145, v129
  v_mul_f32 v146, v146, v130
  v_mul_f32 v147, v147, v131
  v_mul_f32 v152, v152, v136
  v_mul_f32 v153, v153, v137
  v_mul_f32 v154, v154, v138
  v_mul_f32 v155, v155, v139
  v_cvt_pk_bf16_f32 v144, v144, v145
  v_cvt_pk_bf16_f32 v145, v146, v147
  v_cvt_pk_bf16_f32 v146, v152, v153
  v_cvt_pk_bf16_f32 v147, v154, v155
  buffer_store_dwordx4 v[144:147], v5, s[60:63], s12 offen offset:0 sc1
  v_mul_f32 v148, v148, v132
  v_mul_f32 v149, v149, v133
  v_mul_f32 v150, v150, v134
  v_mul_f32 v151, v151, v135
  v_mul_f32 v156, v156, v140
  v_mul_f32 v157, v157, v141
  v_mul_f32 v158, v158, v142
  v_mul_f32 v159, v159, v143
  v_cvt_pk_bf16_f32 v148, v148, v149
  v_cvt_pk_bf16_f32 v149, v150, v151
  v_cvt_pk_bf16_f32 v150, v156, v157
  v_cvt_pk_bf16_f32 v151, v158, v159
  buffer_store_dwordx4 v[148:151], v5, s[60:63], s12 offen offset:1024 sc1
  buffer_load_dwordx4 a[32:35], v1, s[36:39], s11 offen
  s_waitcnt vmcnt(3)
  s_barrier
  v_and_b32 v13, 1, v0
  v_lshlrev_b32 v13, 3, v13
  s_lshr_b32 s13, s4, 1
  s_and_b32 s101, s4, 1
  s_lshl_b32 s100, s13, 14
  s_lshl_b32 s97, s101, 12
  s_add_u32 s100, s100, s97
  s_add_u32 s100, s100, 131072
  s_lshl_b32 s13, s13, 8
  s_lshl_b32 s101, s101, 4
  s_add_u32 s13, s13, s101
  v_add_u32 v13, s13, v13
  v_and_b32 v205, 31, v0
  v_lshrrev_b32 v206, 5, v0
  v_bfe_u32 v207, v0, 1, 2
  v_xor_b32 v206, v206, v207
  v_and_b32 v207, 1, v0
  v_lshlrev_b32 v207, 2, v207
  v_xor_b32 v206, v206, v207
  v_lshlrev_b32 v206, 4, v206
  v_lshl_add_u32 v205, v205, 7, v206
  v_add_u32 v8, s100, v205
  v_xor_b32 v9, 32, v8
  v_xor_b32 v10, 64, v8
  v_xor_b32 v11, 96, v8
  ds_read_b64_tr_b16 a[0:1], v200 offset:0
  ds_read_b64_tr_b16 a[2:3], v200 offset:2048
  ds_read_b64_tr_b16 a[4:5], v201 offset:0
  ds_read_b64_tr_b16 a[6:7], v201 offset:2048
  ds_read_b64_tr_b16 a[8:9], v200 offset:1024
  ds_read_b64_tr_b16 a[10:11], v200 offset:3072
  ds_read_b64_tr_b16 a[12:13], v201 offset:1024
  ds_read_b64_tr_b16 a[14:15], v201 offset:3072
  ds_read_b64_tr_b16 a[16:17], v200 offset:4096
  ds_read_b64_tr_b16 a[18:19], v200 offset:6144
  ds_read_b64_tr_b16 a[20:21], v201 offset:4096
  ds_read_b64_tr_b16 a[22:23], v201 offset:6144
  ds_read_b64_tr_b16 a[24:25], v200 offset:5120
  ds_read_b64_tr_b16 a[26:27], v200 offset:7168
  ds_read_b64_tr_b16 a[28:29], v201 offset:5120
  ds_read_b64_tr_b16 a[30:31], v201 offset:7168
  ds_read_b64_tr_b16 v[72:73], v200 offset:8192
  ds_read_b64_tr_b16 v[74:75], v200 offset:10240
  ds_read_b64_tr_b16 v[76:77], v201 offset:8192
  ds_read_b64_tr_b16 v[78:79], v201 offset:10240
  ds_read_b64_tr_b16 v[80:81], v200 offset:9216
  ds_read_b64_tr_b16 v[82:83], v200 offset:11264
  ds_read_b64_tr_b16 v[84:85], v201 offset:9216
  ds_read_b64_tr_b16 v[86:87], v201 offset:11264
  ds_read_b64_tr_b16 v[88:89], v200 offset:12288
  ds_read_b64_tr_b16 v[90:91], v200 offset:14336
  ds_read_b64_tr_b16 v[92:93], v201 offset:12288
  ds_read_b64_tr_b16 v[94:95], v201 offset:14336
  ds_read_b64_tr_b16 v[96:97], v200 offset:13312
  ds_read_b64_tr_b16 v[98:99], v200 offset:15360
  ds_read_b64_tr_b16 v[100:101], v201 offset:13312
  ds_read_b64_tr_b16 v[102:103], v201 offset:15360
  ds_read_b64_tr_b16 v[104:105], v200 offset:16384
  ds_read_b64_tr_b16 v[106:107], v200 offset:18432
  ds_read_b64_tr_b16 v[108:109], v201 offset:16384
  ds_read_b64_tr_b16 v[110:111], v201 offset:18432
  ds_read_b64_tr_b16 v[112:113], v200 offset:17408
  ds_read_b64_tr_b16 v[114:115], v200 offset:19456
  ds_read_b64_tr_b16 v[116:117], v201 offset:17408
  ds_read_b64_tr_b16 v[118:119], v201 offset:19456
  ds_read_b64_tr_b16 v[160:161], v200 offset:20480
  ds_read_b64_tr_b16 v[162:163], v200 offset:22528
  ds_read_b64_tr_b16 v[164:165], v201 offset:20480
  ds_read_b64_tr_b16 v[166:167], v201 offset:22528
  ds_read_b64_tr_b16 v[168:169], v200 offset:21504
  ds_read_b64_tr_b16 v[170:171], v200 offset:23552
  ds_read_b64_tr_b16 v[172:173], v201 offset:21504
  ds_read_b64_tr_b16 v[174:175], v201 offset:23552
  ds_read_b64_tr_b16 v[176:177], v200 offset:24576
  ds_read_b64_tr_b16 v[178:179], v200 offset:26624
  ds_read_b64_tr_b16 v[180:181], v201 offset:24576
  ds_read_b64_tr_b16 v[182:183], v201 offset:26624
  ds_read_b64_tr_b16 v[184:185], v200 offset:25600
  ds_read_b64_tr_b16 v[186:187], v200 offset:27648
  ds_read_b64_tr_b16 v[188:189], v201 offset:25600
  ds_read_b64_tr_b16 v[190:191], v201 offset:27648
  s_waitcnt lgkmcnt(0)
  s_barrier
  s_waitcnt vmcnt(1)
  s_mov_b64 exec, 1
  buffer_store_dwordx2 v[14:15], off, s[60:63], s14 offset:2048 sc1
  s_mov_b64 exec, -1
  s_barrier
  buffer_load_dwordx2 v[6:7], v13, s[60:63], s10 offen offset:3072 sc1
  s_waitcnt vmcnt(0)
  v_cmp_ne_u64 vcc, v[6:7], v[14:15]
  s_cbranch_vccnz SLOW6
BACK6:
  s_setprio 2
  s_add_u32 s101, s59, 0
  buffer_load_dwordx4 v[16:19], v5, s[60:63], s101 offen offset:0 sc1
  buffer_load_dwordx4 v[20:23], v5, s[60:63], s101 offen offset:1024 sc1
  s_add_u32 s101, s59, 2048
  buffer_load_dwordx4 v[24:27], v5, s[60:63], s101 offen offset:0 sc1
  buffer_load_dwordx4 v[28:31], v5, s[60:63], s101 offen offset:1024 sc1
  s_add_u32 s101, s59, 4096
  buffer_load_dwordx4 v[32:35], v5, s[60:63], s101 offen offset:0 sc1
  buffer_load_dwordx4 v[36:39], v5, s[60:63], s101 offen offset:1024 sc1
  s_add_u32 s101, s59, 6144
  buffer_load_dwordx4 v[40:43], v5, s[60:63], s101 offen offset:0 sc1
  buffer_load_dwordx4 v[44:47], v5, s[60:63], s101 offen offset:1024 sc1
  s_add_u32 s101, s59, 8192
  buffer_load_dwordx4 v[48:51], v5, s[60:63], s101 offen offset:0 sc1
  buffer_load_dwordx4 v[52:55], v5, s[60:63], s101 offen offset:1024 sc1
  s_add_u32 s101, s59, 10240
  buffer_load_dwordx4 v[56:59], v5, s[60:63], s101 offen offset:0 sc1
  buffer_load_dwordx4 v[60:63], v5, s[60:63], s101 offen offset:1024 sc1
  s_add_u32 s101, s59, 12288
  buffer_load_dwordx4 v[64:67], v5, s[60:63], s101 offen offset:0 sc1
  buffer_load_dwordx4 v[68:71], v5, s[60:63], s101 offen offset:1024 sc1
  s_waitcnt vmcnt(12)
  v_mfma_f32_32x32x16_bf16 v[128:143], a[0:3], v[16:19], 0
  v_mfma_f32_32x32x16_bf16 v[144:159], a[4:7], v[16:19], 0
  v_mfma_f32_32x32x16_bf16 v[128:143], a[8:11], v[20:23], v[128:143]
  v_mfma_f32_32x32x16_bf16 v[144:159], a[12:15], v[20:23], v[144:159]
  s_waitcnt vmcnt(10)
  v_mfma_f32_32x32x16_bf16 v[128:143], a[16:19], v[24:27], v[128:143]
  v_mfma_f32_32x32x16_bf16 v[144:159], a[20:23], v[24:27], v[144:159]
  v_mfma_f32_32x32x16_bf16 v[128:143], a[24:27], v[28:31], v[128:143]
  v_mfma_f32_32x32x16_bf16 v[144:159], a[28:31], v[28:31], v[144:159]
  s_waitcnt vmcnt(8)
  v_mfma_f32_32x32x16_bf16 v[128:143], v[72:75], v[32:35], v[128:143]
  v_mfma_f32_32x32x16_bf16 v[144:159], v[76:79], v[32:35], v[144:159]
  v_mfma_f32_32x32x16_bf16 v[128:143], v[80:83], v[36:39], v[128:143]
  v_mfma_f32_32x32x16_bf16 v[144:159], v[84:87], v[36:39], v[144:159]
  s_waitcnt vmcnt(6)
  v_mfma_f32_32x32x16_bf16 v[128:143], v[88:91], v[40:43], v[128:143]
  v_mfma_f32_32x32x16_bf16 v[144:159], v[92:95], v[40:43], v[144:159]
  v_mfma_f32_32x32x16_bf16 v[128:143], v[96:99], v[44:47], v[128:143]
  v_mfma_f32_32x32x16_bf16 v[144:159], v[100:103], v[44:47], v[144:159]
  s_waitcnt vmcnt(4)
  v_mfma_f32_32x32x16_bf16 v[128:143], v[104:107], v[48:51], v[128:143]
  v_mfma_f32_32x32x16_bf16 v[144:159], v[108:111], v[48:51], v[144:159]
  v_mfma_f32_32x32x16_bf16 v[128:143], v[112:115], v[52:55], v[128:143]
  v_mfma_f32_32x32x16_bf16 v[144:159], v[116:119], v[52:55], v[144:159]
  s_waitcnt vmcnt(2)
  v_mfma_f32_32x32x16_bf16 v[128:143], v[160:163], v[56:59], v[128:143]
  v_mfma_f32_32x32x16_bf16 v[144:159], v[164:167], v[56:59], v[144:159]
  v_mfma_f32_32x32x16_bf16 v[128:143], v[168:171], v[60:63], v[128:143]
  v_mfma_f32_32x32x16_bf16 v[144:159], v[172:175], v[60:63], v[144:159]
  s_waitcnt vmcnt(0)
  v_mfma_f32_32x32x16_bf16 v[128:143], v[176:179], v[64:67], v[128:143]
  v_mfma_f32_32x32x16_bf16 v[144:159], v[180:183], v[64:67], v[144:159]
  v_mfma_f32_32x32x16_bf16 v[128:143], v[184:187], v[68:71], v[128:143]
  v_mfma_f32_32x32x16_bf16 v[144:159], v[188:191], v[68:71], v[144:159]
  s_nop 10
  ds_write_b128 v8, v[128:131] offset:0
  ds_write_b128 v9, v[132:135] offset:0
  ds_write_b128 v10, v[136:139] offset:0
  ds_write_b128 v11, v[140:143] offset:0
  ds_write_b128 v8, v[144:147] offset:8192
  ds_write_b128 v9, v[148:151] offset:8192
  ds_write_b128 v10, v[152:155] offset:8192
  ds_write_b128 v11, v[156:159] offset:8192
  v_lshrrev_b32 v2, 3, v0
  v_and_b32 v3, 3, v0
  v_lshlrev_b32 v3, 1, v3
  v_lshrrev_b32 v4, 4, v0
  v_xor_b32 v3, v3, v4
  v_bfe_u32 v4, v0, 3, 1
  v_lshlrev_b32 v4, 2, v4
  v_xor_b32 v3, v3, v4
  v_lshlrev_b32 v3, 4, v3
  v_lshl_add_u32 v3, v2, 7, v3
  v_bfe_u32 v4, v0, 2, 1
  s_lshl_b32 s13, s4, 10
  s_lshl_b32 s100, s56, 15
  s_add_u32 s100, s100, s13
  s_lshl_b32 s101, s56, 14
  s_add_u32 s101, s101, s13
  s_add_u32 s101, s101, 131072
  v_lshl_add_u32 v192, v4, 14, v3
  v_lshl_add_u32 v194, v4, 13, v3
  v_add_u32 v192, s100, v192
  v_xor_b32 v193, 16, v192
  v_add_u32 v194, s101, v194
  v_xor_b32 v195, 16, v194
  v_accvgpr_read_b32 v204, a32
  v_accvgpr_read_b32 v205, a33
  v_accvgpr_read_b32 v206, a34
  v_accvgpr_read_b32 v207, a35
P2DONE:
  s_waitcnt lgkmcnt(0)
  s_barrier
  ds_read_b128 v[32:35], v192 offset:0
  ds_read_b128 v[36:39], v193 offset:0
  ds_read_b128 v[40:43], v192 offset:4096
  ds_read_b128 v[44:47], v193 offset:4096
  ds_read_b128 v[48:51], v192 offset:8192
  ds_read_b128 v[52:55], v193 offset:8192
  ds_read_b128 v[56:59], v192 offset:12288
  ds_read_b128 v[60:63], v193 offset:12288
  ds_read_b128 v[64:67], v194 offset:0
  ds_read_b128 v[68:71], v195 offset:0
  ds_read_b128 v[72:75], v194 offset:4096
  ds_read_b128 v[76:79], v195 offset:4096
  v_lshlrev_b32 v24, 16, v204
  v_and_b32 v25, 0xffff0000, v204
  v_lshlrev_b32 v26, 16, v205
  v_and_b32 v27, 0xffff0000, v205
  v_lshlrev_b32 v28, 16, v206
  v_and_b32 v29, 0xffff0000, v206
  v_lshlrev_b32 v30, 16, v207
  v_and_b32 v31, 0xffff0000, v207
  s_waitcnt lgkmcnt(8)
  v_add_f32 v32, v32, v40
  v_add_f32 v33, v33, v41
  v_add_f32 v34, v34, v42
  v_add_f32 v35, v35, v43
  v_add_f32 v36, v36, v44
  v_add_f32 v37, v37, v45
  v_add_f32 v38, v38, v46
  v_add_f32 v39, v39, v47
  s_waitcnt lgkmcnt(4)
  v_add_f32 v48, v48, v56
  v_add_f32 v49, v49, v57
  v_add_f32 v50, v50, v58
  v_add_f32 v51, v51, v59
  v_add_f32 v52, v52, v60
  v_add_f32 v53, v53, v61
  v_add_f32 v54, v54, v62
  v_add_f32 v55, v55, v63
  v_add_f32 v32, v32, v48
  v_add_f32 v33, v33, v49
  v_add_f32 v34, v34, v50
  v_add_f32 v35, v35, v51
  v_add_f32 v36, v36, v52
  v_add_f32 v37, v37, v53
  v_add_f32 v38, v38, v54
  v_add_f32 v39, v39, v55
  v_mul_f32 v40, 0xbfb8aa3b, v32
  v_mul_f32 v41, 0xbfb8aa3b, v33
  v_mul_f32 v42, 0xbfb8aa3b, v34
  v_mul_f32 v43, 0xbfb8aa3b, v35
  v_mul_f32 v44, 0xbfb8aa3b, v36
  v_mul_f32 v45, 0xbfb8aa3b, v37
  v_mul_f32 v46, 0xbfb8aa3b, v38
  v_mul_f32 v47, 0xbfb8aa3b, v39
  v_exp_f32 v40, v40
  v_exp_f32 v41, v41
  v_exp_f32 v42, v42
  v_exp_f32 v43, v43
  v_exp_f32 v44, v44
  v_exp_f32 v45, v45
  v_exp_f32 v46, v46
  v_exp_f32 v47, v47
  s_waitcnt lgkmcnt(0)
  v_add_f32 v64, v64, v72
  v_add_f32 v65, v65, v73
  v_add_f32 v66, v66, v74
  v_add_f32 v67, v67, v75
  v_add_f32 v68, v68, v76
  v_add_f32 v69, v69, v77
  v_add_f32 v70, v70, v78
  v_add_f32 v71, v71, v79
  v_add_f32 v40, 1.0, v40
  v_add_f32 v41, 1.0, v41
  v_add_f32 v42, 1.0, v42
  v_add_f32 v43, 1.0, v43
  v_add_f32 v44, 1.0, v44
  v_add_f32 v45, 1.0, v45
  v_add_f32 v46, 1.0, v46
  v_add_f32 v47, 1.0, v47
  v_rcp_f32 v40, v40
  v_rcp_f32 v41, v41
  v_rcp_f32 v42, v42
  v_rcp_f32 v43, v43
  v_rcp_f32 v44, v44
  v_rcp_f32 v45, v45
  v_rcp_f32 v46, v46
  v_rcp_f32 v47, v47
  v_mul_f32 v32, v32, v64
  v_mul_f32 v33, v33, v65
  v_mul_f32 v34, v34, v66
  v_mul_f32 v35, v35, v67
  v_mul_f32 v36, v36, v68
  v_mul_f32 v37, v37, v69
  v_mul_f32 v38, v38, v70
  v_mul_f32 v39, v39, v71
  v_fmac_f32 v24, v32, v40
  v_fmac_f32 v25, v33, v41
  v_fmac_f32 v26, v34, v42
  v_fmac_f32 v27, v35, v43
  v_fmac_f32 v28, v36, v44
  v_fmac_f32 v29, v37, v45
  v_fmac_f32 v30, v38, v46
  v_fmac_f32 v31, v39, v47
  v_cvt_pk_bf16_f32 v48, v24, v25
  v_cvt_pk_bf16_f32 v49, v26, v27
  v_cvt_pk_bf16_f32 v50, v28, v29
  v_cvt_pk_bf16_f32 v51, v30, v31
  buffer_store_dwordx4 v[48:51], v1, s[64:67], s11 offen
  s_endpgm
LIGHT:
  v_add_u32 v6, 128, v7
  s_add_u32 m0, s94, 65536
  s_nop 0
  buffer_load_dwordx4 v144, s[36:39], s72 offen offset:0 lds
  buffer_load_dwordx4 v145, s[36:39], s72 offen offset:1024 lds
  s_add_u32 m0, s93, 147456
  s_nop 0
  buffer_load_dwordx4 v7, s[40:43], s79 offen lds
  s_add_u32 m0, s94, 81920
  s_nop 0
  buffer_load_dwordx4 v144, s[36:39], s73 offen offset:0 lds
  buffer_load_dwordx4 v145, s[36:39], s73 offen offset:1024 lds
  s_add_u32 m0, s93, 155648
  s_nop 0
  buffer_load_dwordx4 v7, s[40:43], s80 offen lds
  s_mov_b32 s60, s34
  s_mov_b32 s61, s35
  s_mov_b32 s62, 16777216
  s_mov_b32 s63, 0x00020000
  s_mov_b32 s68, s32
  s_mov_b32 s69, s33
  s_mov_b32 s70, 256
  s_mov_b32 s71, 0x00020000
  s_or_b32 s100, s2, s57
  s_cmp_lg_u32 s100, 0
  s_cbranch_scc1 NONONCE7
  s_or_b32 s98, s98, 1
  v_mov_b32 v14, s98
  v_mov_b32 v15, s99
  s_mov_b64 exec, 1
  buffer_store_dwordx2 v[14:15], off, s[68:71], 0 sc1
  s_mov_b64 exec, -1
NONONCE7:
  s_lshl_b32 s14, s5, 12
  s_lshl_b32 s100, s4, 8
  s_add_u32 s14, s14, s100
  s_lshl_b32 s100, s6, 1
  s_add_u32 s100, s100, s56
  s_lshl_b32 s100, s100, 3
  s_add_u32 s14, s14, s100
  s_add_u32 s14, s14, 14680064
  s_lshl_b32 s100, s56, 1
  s_xor_b32 s100, s100, s4
  v_lshrrev_b32 v188, 5, v0
  v_bfe_u32 v189, v0, 2, 2
  v_bfe_u32 v191, v0, 3, 1
  v_lshlrev_b32 v191, 6, v191
  v_bfe_u32 v192, v0, 4, 1
  v_lshl_add_u32 v191, v192, 5, v191
  v_and_b32 v193, 3, v0
  v_lshl_add_u32 v191, v193, 3, v191
  v_lshl_add_u32 v190, v188, 3, v189
  v_lshl_add_u32 v1, v190, 7, v191
  s_lshl_b32 s13, s100, 11
  s_lshl_b32 s101, s56, 6
  s_add_u32 s13, s13, s101
  v_xor_b32 v1, s13, v1
  v_xor_b32 v2, 2048, v1
  v_xor_b32 v3, 4096, v1
  v_xor_b32 v4, 6144, v1
  v_lshl_add_u32 v190, v188, 2, v189
  v_lshl_add_u32 v200, v190, 7, v191
  v_add_u32 v200, s58, v200
  v_xor_b32 v201, 64, v200
  v_and_b32 v189, 31, v0
  v_bfe_u32 v190, v0, 1, 3
  v_xor_b32 v190, v190, v188
  v_lshlrev_b32 v190, 4, v190
  v_lshl_add_u32 v190, v189, 7, v190
  s_lshl_b32 s13, s100, 5
  s_lshl_b32 s101, s4, 12
  s_add_u32 s13, s13, s101
  v_xor_b32 v146, s13, v190
  v_xor_b32 v147, 32, v146
  v_xor_b32 v148, 64, v146
  v_xor_b32 v149, 96, v146
  s_lshl_b32 s13, s56, 9
  s_add_u32 s13, s13, 147456
  v_lshlrev_b32 v11, 4, v189
  v_add_u32 v11, s13, v11
  s_lshl_b32 s13, s4, 2
  v_add_u32 v12, s13, v11
  v_and_b32 v193, 15, v0
  v_lshrrev_b32 v194, 4, v0
  v_bfe_u32 v195, v0, 1, 3
  v_xor_b32 v195, v195, v194
  v_lshlrev_b32 v195, 4, v195
  v_lshl_add_u32 v195, v193, 7, v195
  v_add_u32 v150, s94, v195
  v_xor_b32 v151, 64, v150
  v_bfe_u32 v195, v0, 2, 2
  v_cmp_eq_u32 vcc, v195, v194
  s_lshr_b32 s13, s94, 7
  v_add_u32 v193, s13, v193
  v_add_u32 v194, 128, v0
  v_cndmask_b32 v204, v194, v193, vcc
  v_mov_b32 v160, 0x3f803f80
  v_mov_b32 v161, 0x3f803f80
  v_mov_b32 v162, 0x3f803f80
  v_mov_b32 v163, 0x3f803f80
  v_lshlrev_b32 v5, 4, v0
  v_and_b32 v189, 15, v0
  v_lshlrev_b32 v189, 4, v189
  v_lshl_add_u32 v189, v188, 8, v189
  v_lshl_add_u32 v202, v192, 10, v189
  v_bfe_u32 v189, v0, 2, 1
  v_cmp_eq_u32 vcc, v189, v192
  v_mov_b32 v190, 0x3f803f80
  v_mov_b32 v203, 0
  v_cndmask_b32 v176, 0, v190, vcc
  v_mov_b32 v177, v176
  v_mov_b32 v178, v176
  v_mov_b32 v179, v176
  v_mov_b32 v181, 0
  v_mov_b32 v183, 0
  s_add_u32 m0, s94, 98304
  s_nop 0
  buffer_load_dwordx4 v144, s[36:39], s74 offen offset:0 lds
  buffer_load_dwordx4 v145, s[36:39], s74 offen offset:1024 lds
  s_add_u32 m0, s93, 131072
  s_nop 0
  buffer_load_dwordx4 v7, s[40:43], s81 offen lds
  s_add_u32 m0, s94, 0
  s_nop 0
  buffer_load_dwordx4 v144, s[36:39], s75 offen offset:0 lds
  buffer_load_dwordx4 v145, s[36:39], s75 offen offset:1024 lds
  s_add_u32 m0, s93, 139264
  s_nop 0
  buffer_load_dwordx4 v7, s[40:43], s82 offen lds
  v_and_b32 v13, 31, v0
  v_min_u32 v13, 27, v13
  v_lshlrev_b32 v13, 3, v13
  s_lshl_b32 s10, s5, 2
  s_add_u32 s10, s10, s4
  s_sub_u32 s11, s10, 1
  s_max_i32 s11, s11, 0
  s_lshr_b32 s13, s10, 2
  s_lshl_b32 s13, s13, 12
  s_and_b32 s3, s10, 3
  s_lshl_b32 s3, s3, 8
  s_add_u32 s13, s13, s3
  s_lshr_b32 s101, s11, 2
  s_lshl_b32 s101, s101, 12
  s_and_b32 s3, s11, 3
  s_lshl_b32 s3, s3, 8
  s_add_u32 s101, s101, s3
  v_mov_b32 v188, s13
  v_mov_b32 v189, s101
  v_cmp_gt_u32 vcc, 32, v0
  s_nop 1
  v_cndmask_b32 v188, v189, v188, vcc
  v_add_u32 v13, v13, v188
  s_mov_b32 s12, 14680064
  s_mul_i32 s59, s10, 143488
  s_mul_i32 s13, s6, 14336
  s_add_u32 s59, s59, s13
  s_add_u32 s59, s59, 114688
  s_cmp_eq_u32 s10, 0
  s_cselect_b32 s96, 0xf149f2ca, 0
  s_mul_i32 s10, s10, 57472
  s_mul_i32 s11, s11, 57472
  s_add_u32 s13, s13, 10485760
  s_add_u32 s10, s10, s13
  s_add_u32 s11, s11, s13
  s_lshl_b32 s13, s4, 12
  s_sub_u32 s100, s56, s6
  s_add_u32 s100, s100, 1
  s_lshl_b32 s101, s100, 11
  s_cmp_eq_u32 s100, 2
  s_cselect_b32 s101, 16384, s101
  s_add_u32 s101, s101, s13
  v_add_u32 v198, s101, v202
  v_add_u32 v199, s13, v5
  s_waitcnt vmcnt(9)
  s_barrier
  v_add_u32 v146, 65536, v146
  ds_read_b128 v[16:19], v146 offset:0
  v_add_u32 v147, 65536, v147
  ds_read_b128 v[20:23], v147 offset:0
  v_add_u32 v148, 65536, v148
  ds_read_b128 v[24:27], v148 offset:0
  v_add_u32 v149, 65536, v149
  ds_read_b128 v[28:31], v149 offset:0
  v_add_u32 v150, 65536, v150
  ds_read_b128 a[32:35], v150 offset:0
  v_add_u32 v151, 65536, v151
  ds_read_b128 a[36:39], v151 offset:0
  v_add_u32 v1, 131072, v1
  ds_read_b64_tr_b16 a[0:1], v1 offset:16384
  ds_read_b64_tr_b16 a[2:3], v1 offset:16896
  v_add_u32 v2, 131072, v2
  ds_read_b64_tr_b16 a[4:5], v2 offset:16384
  ds_read_b64_tr_b16 a[6:7], v2 offset:16896
  v_add_u32 v3, 131072, v3
  ds_read_b64_tr_b16 a[8:9], v3 offset:16384
  ds_read_b64_tr_b16 a[10:11], v3 offset:16896
  v_add_u32 v4, 131072, v4
  ds_read_b64_tr_b16 a[12:13], v4 offset:16384
  ds_read_b64_tr_b16 a[14:15], v4 offset:16896
  s_add_u32 m0, s94, 16384
  s_nop 0
  buffer_load_dwordx4 v144, s[36:39], s76 offen offset:0 lds
  buffer_load_dwordx4 v145, s[36:39], s76 offen offset:1024 lds
  s_add_u32 m0, s93, 114688
  s_nop 0
  buffer_load_dwordx4 v7, s[40:43], s83 offen lds
  s_waitcnt lgkmcnt(8)
  s_waitcnt vmcnt(9)
  s_barrier
  s_waitcnt lgkmcnt(4)
  v_mfma_f32_32x32x16_bf16 v[128:143], a[0:3], v[16:19], 0
  ds_read_b64_tr_b16 a[16:17], v1 offset:24576
  ds_read_b64_tr_b16 a[18:19], v1 offset:25088
  s_add_u32 m0, s94, 32768
  s_nop 0
  buffer_load_dwordx4 v144, s[36:39], s77 offen offset:0 lds
  v_mfma_f32_16x16x32_bf16 v[152:155], v[160:163], a[32:35], 0
  v_mfma_f32_16x16x32_bf16 v[156:159], a[32:35], a[32:35], 0
  v_mfma_f32_16x16x32_bf16 v[152:155], v[160:163], a[36:39], v[152:155]
  v_mfma_f32_16x16x32_bf16 v[156:159], a[36:39], a[36:39], v[156:159]
  ds_read_b128 v[32:35], v146 offset:16384
  ds_read_b128 v[36:39], v147 offset:16384
  ds_read_b128 v[40:43], v148 offset:16384
  ds_read_b128 v[44:47], v149 offset:16384
  ds_read_b128 a[32:35], v150 offset:16384
  ds_read_b128 a[36:39], v151 offset:16384
  v_mfma_f32_32x32x16_bf16 v[128:143], a[4:7], v[20:23], v[128:143]
  ds_read_b64_tr_b16 a[20:21], v2 offset:24576
  ds_read_b64_tr_b16 a[22:23], v2 offset:25088
  buffer_load_dwordx4 v145, s[36:39], s77 offen offset:1024 lds
  v_mfma_f32_16x16x32_bf16 v[184:187], v[176:179], a[0:3], 0
  s_waitcnt lgkmcnt(10)
  v_mfma_f32_32x32x16_bf16 v[128:143], a[8:11], v[24:27], v[128:143]
  ds_read_b64_tr_b16 a[24:25], v3 offset:24576
  ds_read_b64_tr_b16 a[26:27], v3 offset:25088
  s_add_u32 m0, s93, 122880
  s_nop 0
  buffer_load_dwordx4 v7, s[40:43], s84 offen lds
  v_mfma_f32_32x32x16_bf16 v[128:143], a[12:15], v[28:31], v[128:143]
  ds_read_b64_tr_b16 a[28:29], v4 offset:24576
  ds_read_b64_tr_b16 a[30:31], v4 offset:25088
  s_add_u32 m0, s94, 49152
  s_nop 0
  buffer_load_dwordx4 v144, s[36:39], s78 offen offset:0 lds
  s_waitcnt lgkmcnt(6)
  s_waitcnt vmcnt(10)
  s_barrier
  s_waitcnt lgkmcnt(4)
  v_mfma_f32_32x32x16_bf16 v[128:143], a[16:19], v[32:35], v[128:143]
  ds_read_b64_tr_b16 a[0:1], v1 offset:0
  ds_read_b64_tr_b16 a[2:3], v1 offset:512
  buffer_load_dwordx4 v145, s[36:39], s78 offen offset:1024 lds
  v_mfma_f32_16x16x32_bf16 v[152:155], v[160:163], a[32:35], v[152:155]
  v_mfma_f32_16x16x32_bf16 v[156:159], a[32:35], a[32:35], v[156:159]
  v_mfma_f32_16x16x32_bf16 v[152:155], v[160:163], a[36:39], v[152:155]
  v_mfma_f32_16x16x32_bf16 v[156:159], a[36:39], a[36:39], v[156:159]
  ds_read_b128 v[48:51], v146 offset:32768
  ds_read_b128 v[52:55], v147 offset:32768
  ds_read_b128 v[56:59], v148 offset:32768
  ds_read_b128 v[60:63], v149 offset:32768
  ds_read_b128 a[32:35], v150 offset:32768
  ds_read_b128 a[36:39], v151 offset:32768
  v_mfma_f32_32x32x16_bf16 v[128:143], a[20:23], v[36:39], v[128:143]
  ds_read_b64_tr_b16 a[4:5], v2 offset:0
  ds_read_b64_tr_b16 a[6:7], v2 offset:512
  s_add_u32 m0, s93, 65536
  s_nop 0
  buffer_load_dwordx4 v7, s[40:43], s85 offen lds
  v_mfma_f32_16x16x32_bf16 v[184:187], v[176:179], a[16:19], v[184:187]
  s_waitcnt lgkmcnt(10)
  v_mfma_f32_32x32x16_bf16 v[128:143], a[24:27], v[40:43], v[128:143]
  ds_read_b64_tr_b16 a[8:9], v3 offset:0
  ds_read_b64_tr_b16 a[10:11], v3 offset:512
  s_add_u32 m0, s93, 73728
  s_add_u32 s40, s40, 128
  s_addc_u32 s41, s41, 0
  s_sub_u32 s42, s42, 128
  buffer_load_dwordx4 v7, s[40:43], s79 offen lds
  v_mfma_f32_32x32x16_bf16 v[128:143], a[28:31], v[44:47], v[128:143]
  ds_read_b64_tr_b16 a[12:13], v4 offset:0
  ds_read_b64_tr_b16 a[14:15], v4 offset:512
  s_add_u32 m0, s93, 81920
  s_nop 0
  buffer_load_dwordx4 v7, s[40:43], s80 offen lds
  s_waitcnt lgkmcnt(6)
  s_waitcnt vmcnt(11)
  s_barrier
  s_waitcnt lgkmcnt(4)
  v_mfma_f32_32x32x16_bf16 v[128:143], a[0:3], v[48:51], v[128:143]
  ds_read_b64_tr_b16 a[16:17], v1 offset:8192
  ds_read_b64_tr_b16 a[18:19], v1 offset:8704
  s_add_u32 m0, s93, 90112
  s_nop 0
  buffer_load_dwordx4 v7, s[40:43], s81 offen lds
  v_mfma_f32_16x16x32_bf16 v[152:155], v[160:163], a[32:35], v[152:155]
  v_mfma_f32_16x16x32_bf16 v[156:159], a[32:35], a[32:35], v[156:159]
  v_mfma_f32_16x16x32_bf16 v[152:155], v[160:163], a[36:39], v[152:155]
  v_mfma_f32_16x16x32_bf16 v[156:159], a[36:39], a[36:39], v[156:159]
  v_add_u32 v146, 4294901760, v146
  ds_read_b128 v[64:67], v146 offset:0
  v_add_u32 v147, 4294901760, v147
  ds_read_b128 v[68:71], v147 offset:0
  v_add_u32 v148, 4294901760, v148
  ds_read_b128 v[72:75], v148 offset:0
  v_add_u32 v149, 4294901760, v149
  ds_read_b128 v[76:79], v149 offset:0
  v_add_u32 v150, 4294901760, v150
  ds_read_b128 a[32:35], v150 offset:0
  v_add_u32 v151, 4294901760, v151
  ds_read_b128 a[36:39], v151 offset:0
  v_mfma_f32_32x32x16_bf16 v[128:143], a[4:7], v[52:55], v[128:143]
  ds_read_b64_tr_b16 a[20:21], v2 offset:8192
  ds_read_b64_tr_b16 a[22:23], v2 offset:8704
  s_add_u32 m0, s93, 98304
  s_nop 0
  buffer_load_dwordx4 v7, s[40:43], s82 offen lds
  v_mfma_f32_16x16x32_bf16 v[184:187], v[176:179], a[0:3], v[184:187]
  s_waitcnt lgkmcnt(10)
  v_mfma_f32_32x32x16_bf16 v[128:143], a[8:11], v[56:59], v[128:143]
  ds_read_b64_tr_b16 a[24:25], v3 offset:8192
  ds_read_b64_tr_b16 a[26:27], v3 offset:8704
  s_add_u32 m0, s93, 106496
  s_nop 0
  buffer_load_dwordx4 v7, s[40:43], s83 offen lds
  v_mfma_f32_32x32x16_bf16 v[128:143], a[12:15], v[60:63], v[128:143]
  ds_read_b64_tr_b16 a[28:29], v4 offset:8192
  ds_read_b64_tr_b16 a[30:31], v4 offset:8704
  s_waitcnt lgkmcnt(6)
  s_waitcnt vmcnt(11)
  s_barrier
  s_waitcnt lgkmcnt(4)
  v_mfma_f32_32x32x16_bf16 v[128:143], a[16:19], v[64:67], v[128:143]
  v_add_u32 v1, 4294901760, v1
  ds_read_b64_tr_b16 a[0:1], v1 offset:49152
  ds_read_b64_tr_b16 a[2:3], v1 offset:49664
  v_mfma_f32_16x16x32_bf16 v[152:155], v[160:163], a[32:35], v[152:155]
  v_mfma_f32_16x16x32_bf16 v[156:159], a[32:35], a[32:35], v[156:159]
  v_mfma_f32_16x16x32_bf16 v[152:155], v[160:163], a[36:39], v[152:155]
  v_mfma_f32_16x16x32_bf16 v[156:159], a[36:39], a[36:39], v[156:159]
  ds_read_b128 v[80:83], v146 offset:16384
  ds_read_b128 v[84:87], v147 offset:16384
  ds_read_b128 v[88:91], v148 offset:16384
  ds_read_b128 v[92:95], v149 offset:16384
  ds_read_b128 a[32:35], v150 offset:16384
  ds_read_b128 a[36:39], v151 offset:16384
  v_mfma_f32_32x32x16_bf16 v[128:143], a[20:23], v[68:71], v[128:143]
  v_add_u32 v2, 4294901760, v2
  ds_read_b64_tr_b16 a[4:5], v2 offset:49152
  ds_read_b64_tr_b16 a[6:7], v2 offset:49664
  v_mfma_f32_16x16x32_bf16 v[184:187], v[176:179], a[16:19], v[184:187]
  s_waitcnt lgkmcnt(10)
  v_mfma_f32_32x32x16_bf16 v[128:143], a[24:27], v[72:75], v[128:143]
  v_add_u32 v3, 4294901760, v3
  ds_read_b64_tr_b16 a[8:9], v3 offset:49152
  ds_read_b64_tr_b16 a[10:11], v3 offset:49664
  v_mfma_f32_32x32x16_bf16 v[128:143], a[28:31], v[76:79], v[128:143]
  v_add_u32 v4, 4294901760, v4
  ds_read_b64_tr_b16 a[12:13], v4 offset:49152
  ds_read_b64_tr_b16 a[14:15], v4 offset:49664
  s_waitcnt lgkmcnt(6)
  s_waitcnt vmcnt(8)
  s_barrier
  s_waitcnt lgkmcnt(4)
  v_mfma_f32_32x32x16_bf16 v[128:143], a[0:3], v[80:83], v[128:143]
  ds_read_b64_tr_b16 a[16:17], v1 offset:57344
  ds_read_b64_tr_b16 a[18:19], v1 offset:57856
  s_add_u32 m0, s93, 131072
  s_nop 0
  buffer_load_dwordx4 v7, s[40:43], s84 offen lds
  v_mfma_f32_16x16x32_bf16 v[152:155], v[160:163], a[32:35], v[152:155]
  v_mfma_f32_16x16x32_bf16 v[156:159], a[32:35], a[32:35], v[156:159]
  v_mfma_f32_16x16x32_bf16 v[152:155], v[160:163], a[36:39], v[152:155]
  v_mfma_f32_16x16x32_bf16 v[156:159], a[36:39], a[36:39], v[156:159]
  ds_read_b128 v[96:99], v146 offset:32768
  ds_read_b128 v[100:103], v147 offset:32768
  ds_read_b128 v[104:107], v148 offset:32768
  ds_read_b128 v[108:111], v149 offset:32768
  ds_read_b128 a[32:35], v150 offset:32768
  ds_read_b128 a[36:39], v151 offset:32768
  buffer_load_dwordx2 v[14:15], v203, s[68:71], 0 offen offset:0 sc1
  v_mfma_f32_32x32x16_bf16 v[128:143], a[4:7], v[84:87], v[128:143]
  ds_read_b64_tr_b16 a[20:21], v2 offset:57344
  ds_read_b64_tr_b16 a[22:23], v2 offset:57856
  s_add_u32 m0, s93, 139264
  s_nop 0
  buffer_load_dwordx4 v7, s[40:43], s85 offen lds
  v_mfma_f32_16x16x32_bf16 v[184:187], v[176:179], a[0:3], v[184:187]
  s_waitcnt lgkmcnt(10)
  v_mfma_f32_32x32x16_bf16 v[128:143], a[8:11], v[88:91], v[128:143]
  ds_read_b64_tr_b16 a[24:25], v3 offset:57344
  ds_read_b64_tr_b16 a[26:27], v3 offset:57856
  v_mfma_f32_32x32x16_bf16 v[128:143], a[12:15], v[92:95], v[128:143]
  ds_read_b64_tr_b16 a[28:29], v4 offset:57344
  ds_read_b64_tr_b16 a[30:31], v4 offset:57856
  s_waitcnt lgkmcnt(6)
  s_waitcnt vmcnt(8)
  s_barrier
  s_waitcnt lgkmcnt(4)
  v_mfma_f32_32x32x16_bf16 v[128:143], a[16:19], v[96:99], v[128:143]
  ds_read_b64_tr_b16 a[0:1], v1 offset:0
  ds_read_b64_tr_b16 a[2:3], v1 offset:512
  v_mfma_f32_16x16x32_bf16 v[152:155], v[160:163], a[32:35], v[152:155]
  v_mfma_f32_16x16x32_bf16 v[156:159], a[32:35], a[32:35], v[156:159]
  v_mfma_f32_16x16x32_bf16 v[152:155], v[160:163], a[36:39], v[152:155]
  v_mfma_f32_16x16x32_bf16 v[156:159], a[36:39], a[36:39], v[156:159]
  ds_read_b128 v[112:115], v146 offset:49152
  ds_read_b128 v[116:119], v147 offset:49152
  ds_read_b128 v[120:123], v148 offset:49152
  ds_read_b128 v[124:127], v149 offset:49152
  ds_read_b128 a[32:35], v150 offset:49152
  ds_read_b128 a[36:39], v151 offset:49152
  v_mfma_f32_32x32x16_bf16 v[128:143], a[20:23], v[100:103], v[128:143]
  ds_read_b64_tr_b16 a[4:5], v2 offset:0
  ds_read_b64_tr_b16 a[6:7], v2 offset:512
  v_mfma_f32_16x16x32_bf16 v[184:187], v[176:179], a[16:19], v[184:187]
  s_waitcnt lgkmcnt(10)
  v_mfma_f32_32x32x16_bf16 v[128:143], a[24:27], v[104:107], v[128:143]
  ds_read_b64_tr_b16 a[8:9], v3 offset:0
  ds_read_b64_tr_b16 a[10:11], v3 offset:512
  s_waitcnt lgkmcnt(4)
  v_mfma_f32_16x16x32_bf16 v[152:155], v[160:163], a[32:35], v[152:155]
  v_mfma_f32_16x16x32_bf16 v[156:159], a[32:35], a[32:35], v[156:159]
  v_mfma_f32_16x16x32_bf16 v[152:155], v[160:163], a[36:39], v[152:155]
  v_mfma_f32_16x16x32_bf16 v[156:159], a[36:39], a[36:39], v[156:159]
  v_mfma_f32_32x32x16_bf16 v[128:143], a[28:31], v[108:111], v[128:143]
  ds_read_b64_tr_b16 a[12:13], v4 offset:0
  ds_read_b64_tr_b16 a[14:15], v4 offset:512
  v_and_b32 v205, 3, v0
  v_cmp_eq_u32 vcc, 1, v205
  s_nop 1
  v_mul_f32 v152, 0xbb124925, v152
  v_lshlrev_b32 v206, 3, v204
  v_cndmask_b32 v153, v156, v157, vcc
  v_cmp_eq_u32 vcc, 2, v205
  v_add_u32 v206, 149504, v206
  v_lshlrev_b32 v207, 2, v204
  v_cndmask_b32 v153, v153, v158, vcc
  v_cmp_eq_u32 vcc, 3, v205
  v_add_u32 v207, 148480, v207
  v_mul_f32 v205, v152, v152
  v_cndmask_b32 v153, v153, v159, vcc
  v_cvt_pk_bf16_f32 v152, v152, v152
  v_mul_f32 v153, 0x3b124925, v153
  v_sub_f32 v153, v153, v205
  v_max_f32 v153, 0, v153
  v_cvt_pk_bf16_f32 v153, v153, v153
  v_and_b32 v153, 0xffff0000, v153
  v_add_f32 v153, 0x3727c5ac, v153
  v_cvt_pk_bf16_f32 v153, v153, v153
  v_and_b32 v153, 0xffff0000, v153
  v_sqrt_f32 v153, v153
  s_nop 0
  v_cvt_pk_bf16_f32 v153, v153, v153
  v_and_b32 v153, 0xffff0000, v153
  v_rcp_f32 v205, v153
  ds_write_b64 v206, v[152:153]
  ds_write_b32 v207, v205
  v_and_b32 v204, 31, v0
  s_lshl_b32 s13, s4, 8
  s_add_u32 s13, s13, 149504
  v_lshlrev_b32 v204, 3, v204
  v_add_u32 v204, s13, v204
  ds_write_b32 v12, v184
  s_waitcnt lgkmcnt(0)
  s_waitcnt vmcnt(7)
  s_barrier
  ds_read_b64 v[154:155], v204
  ds_read_b128 v[188:191], v11
  v_mfma_f32_32x32x16_bf16 v[128:143], a[0:3], v[112:115], v[128:143]
  ds_read_b64_tr_b16 a[16:17], v1 offset:8192
  ds_read_b64_tr_b16 a[18:19], v1 offset:8704
  s_add_u32 m0, s93, 49152
  s_add_u32 s40, s40, 128
  s_addc_u32 s41, s41, 0
  s_sub_u32 s42, s42, 128
  buffer_load_dwordx4 v7, s[40:43], s79 offen lds
  v_mfma_f32_16x16x32_bf16 v[184:187], v[176:179], a[0:3], 0
  v_mfma_f32_32x32x16_bf16 v[128:143], a[4:7], v[116:119], v[128:143]
  ds_read_b64_tr_b16 a[20:21], v2 offset:8192
  ds_read_b64_tr_b16 a[22:23], v2 offset:8704
  s_add_u32 m0, s93, 57344
  s_nop 0
  buffer_load_dwordx4 v6, s[40:43], s79 offen lds
  v_mfma_f32_16x16x32_bf16 v[184:187], v[176:179], a[4:7], v[184:187]
  s_waitcnt lgkmcnt(5)
  v_cmp_gt_u32 vcc, 32, v0
  v_rcp_f32 v10, v155
  v_mul_f32 v9, v155, v155
  v_cndmask_b32 v180, 0, v154, vcc
  v_mul_f32 v8, 0xbfb8aa3b, v10
  v_mfma_f32_32x32x16_bf16 v[128:143], a[8:11], v[120:123], v[128:143]
  ds_read_b64_tr_b16 a[24:25], v3 offset:8192
  ds_read_b64_tr_b16 a[26:27], v3 offset:8704
  s_add_u32 m0, s93, 114688
  s_nop 0
  buffer_load_dwordx4 v7, s[40:43], s80 offen lds
  v_mfma_f32_16x16x32_bf16 v[184:187], v[176:179], a[8:11], v[184:187]
  v_mfma_f32_32x32x16_bf16 v[128:143], a[12:15], v[124:127], v[128:143]
  ds_read_b64_tr_b16 a[28:29], v4 offset:8192
  ds_read_b64_tr_b16 a[30:31], v4 offset:8704
  s_add_u32 m0, s93, 122880
  s_nop 0
  buffer_load_dwordx4 v6, s[40:43], s80 offen lds
  v_mfma_f32_16x16x32_bf16 v[184:187], v[176:179], a[12:15], v[184:187]
  s_waitcnt vmcnt(10)
  s_barrier
  s_waitcnt lgkmcnt(4)
  v_mfma_f32_32x32x16_bf16 v[160:175], a[16:19], v[16:19], 0
  ds_read_b64_tr_b16 a[0:1], v1 offset:16384
  ds_read_b64_tr_b16 a[2:3], v1 offset:16896
  v_add_f32 v188, v188, v189
  v_add_f32 v190, v190, v191
  v_add_f32 v188, v188, v184
  v_add_f32 v188, v188, v190
  v_and_b32 v189, 0xffff0000, v188
  v_sub_f32 v188, v188, v189
  v_mfma_f32_32x32x16_bf16 v[160:175], a[20:23], v[20:23], v[160:175]
  ds_read_b64_tr_b16 a[4:5], v2 offset:16384
  ds_read_b64_tr_b16 a[6:7], v2 offset:16896
  v_mfma_f32_16x16x32_bf16 v[184:187], v[176:179], a[16:19], 0
  v_cvt_pk_bf16_f32 v182, v189, v188
  s_waitcnt lgkmcnt(4)
  v_mfma_f32_32x32x16_bf16 v[160:175], a[24:27], v[24:27], v[160:175]
  ds_read_b64_tr_b16 a[8:9], v3 offset:16384
  ds_read_b64_tr_b16 a[10:11], v3 offset:16896
  v_mfma_f32_32x32x8_bf16 v[128:143], v[182:183], v[180:181], v[128:143]
  v_mfma_f32_32x32x16_bf16 v[160:175], a[28:31], v[28:31], v[160:175]
  ds_read_b64_tr_b16 a[12:13], v4 offset:16384
  ds_read_b64_tr_b16 a[14:15], v4 offset:16896
  s_waitcnt vmcnt(9)
  s_barrier
  s_waitcnt lgkmcnt(4)
  v_mfma_f32_32x32x16_bf16 v[160:175], a[0:3], v[32:35], v[160:175]
  ds_read_b64_tr_b16 a[16:17], v1 offset:24576
  ds_read_b64_tr_b16 a[18:19], v1 offset:25088
  v_mfma_f32_32x32x16_bf16 v[160:175], a[4:7], v[36:39], v[160:175]
  ds_read_b64_tr_b16 a[20:21], v2 offset:24576
  ds_read_b64_tr_b16 a[22:23], v2 offset:25088
  s_add_u32 m0, s93, 65536
  s_nop 0
  buffer_load_dwordx4 v7, s[40:43], s81 offen lds
  v_mfma_f32_16x16x32_bf16 v[184:187], v[176:179], a[0:3], v[184:187]
  v_mul_f32 v128, v128, v10
  s_waitcnt lgkmcnt(4)
  v_mfma_f32_32x32x16_bf16 v[160:175], a[8:11], v[40:43], v[160:175]
  ds_read_b64_tr_b16 a[24:25], v3 offset:24576
  ds_read_b64_tr_b16 a[26:27], v3 offset:25088
  v_mul_f32 v129, v129, v10
  v_mul_f32 v130, v130, v10
  v_mfma_f32_32x32x16_bf16 v[160:175], a[12:15], v[44:47], v[160:175]
  ds_read_b64_tr_b16 a[28:29], v4 offset:24576
  ds_read_b64_tr_b16 a[30:31], v4 offset:25088
  s_add_u32 m0, s93, 73728
  s_nop 0
  buffer_load_dwordx4 v6, s[40:43], s81 offen lds
  v_mul_f32 v131, v131, v10
  s_waitcnt vmcnt(10)
  s_barrier
  s_waitcnt lgkmcnt(4)
  v_mfma_f32_32x32x16_bf16 v[160:175], a[16:19], v[48:51], v[160:175]
  ds_read_b64_tr_b16 a[0:1], v1 offset:32768
  ds_read_b64_tr_b16 a[2:3], v1 offset:33280
  v_mul_f32 v136, v136, v10
  v_mul_f32 v137, v137, v10
  v_mfma_f32_32x32x16_bf16 v[160:175], a[20:23], v[52:55], v[160:175]
  ds_read_b64_tr_b16 a[4:5], v2 offset:32768
  ds_read_b64_tr_b16 a[6:7], v2 offset:33280
  v_mfma_f32_16x16x32_bf16 v[184:187], v[176:179], a[16:19], v[184:187]
  v_mul_f32 v138, v138, v10
  v_mul_f32 v139, v139, v10
  s_waitcnt lgkmcnt(4)
  v_mfma_f32_32x32x16_bf16 v[160:175], a[24:27], v[56:59], v[160:175]
  ds_read_b64_tr_b16 a[8:9], v3 offset:32768
  ds_read_b64_tr_b16 a[10:11], v3 offset:33280
  v_cvt_pk_bf16_f32 v128, v128, v129
  v_cvt_pk_bf16_f32 v129, v130, v131
  v_mfma_f32_32x32x16_bf16 v[160:175], a[28:31], v[60:63], v[160:175]
  ds_read_b64_tr_b16 a[12:13], v4 offset:32768
  ds_read_b64_tr_b16 a[14:15], v4 offset:33280
  v_cvt_pk_bf16_f32 v130, v136, v137
  v_cvt_pk_bf16_f32 v131, v138, v139
  s_waitcnt vmcnt(6)
  s_barrier
  s_waitcnt lgkmcnt(4)
  v_mfma_f32_32x32x16_bf16 v[160:175], a[0:3], v[64:67], v[160:175]
  ds_read_b64_tr_b16 a[16:17], v1 offset:40960
  ds_read_b64_tr_b16 a[18:19], v1 offset:41472
  ds_write_b128 v198, v[128:131] offset:0
  v_mfma_f32_32x32x16_bf16 v[160:175], a[4:7], v[68:71], v[160:175]
  ds_read_b64_tr_b16 a[20:21], v2 offset:40960
  ds_read_b64_tr_b16 a[22:23], v2 offset:41472
  s_add_u32 m0, s93, 81920
  s_nop 0
  buffer_load_dwordx4 v7, s[40:43], s82 offen lds
  v_mfma_f32_16x16x32_bf16 v[184:187], v[176:179], a[0:3], v[184:187]
  v_cmp_eq_u64 vcc, 0, v[14:15]
  s_cbranch_vccnz SLOW8
BACK8:
  v_mul_f32 v132, v132, v10
  v_mul_f32 v133, v133, v10
  s_waitcnt lgkmcnt(5)
  v_mfma_f32_32x32x16_bf16 v[160:175], a[8:11], v[72:75], v[160:175]
  ds_read_b64_tr_b16 a[24:25], v3 offset:40960
  ds_read_b64_tr_b16 a[26:27], v3 offset:41472
  v_mul_f32 v134, v134, v10
  v_mul_f32 v135, v135, v10
  v_mfma_f32_32x32x16_bf16 v[160:175], a[12:15], v[76:79], v[160:175]
  ds_read_b64_tr_b16 a[28:29], v4 offset:40960
  ds_read_b64_tr_b16 a[30:31], v4 offset:41472
  s_add_u32 m0, s93, 90112
  s_nop 0
  buffer_load_dwordx4 v6, s[40:43], s82 offen lds
  v_mul_f32 v140, v140, v10
  v_mul_f32 v141, v141, v10
  s_waitcnt lgkmcnt(4)
  v_mfma_f32_32x32x16_bf16 v[160:175], a[16:19], v[80:83], v[160:175]
  v_add_u32 v1, 65536, v1
  ds_read_b64_tr_b16 a[0:1], v1 offset:0
  ds_read_b64_tr_b16 a[2:3], v1 offset:512
  v_mul_f32 v142, v142, v10
  v_mul_f32 v143, v143, v10
  v_mfma_f32_32x32x16_bf16 v[160:175], a[20:23], v[84:87], v[160:175]
  v_add_u32 v2, 65536, v2
  ds_read_b64_tr_b16 a[4:5], v2 offset:0
  ds_read_b64_tr_b16 a[6:7], v2 offset:512
  v_mfma_f32_16x16x32_bf16 v[184:187], v[176:179], a[16:19], v[184:187]
  v_cvt_pk_bf16_f32 v132, v132, v133
  s_waitcnt lgkmcnt(4)
  v_mfma_f32_32x32x16_bf16 v[160:175], a[24:27], v[88:91], v[160:175]
  v_add_u32 v3, 65536, v3
  ds_read_b64_tr_b16 a[8:9], v3 offset:0
  ds_read_b64_tr_b16 a[10:11], v3 offset:512
  v_cvt_pk_bf16_f32 v133, v134, v135
  v_cvt_pk_bf16_f32 v134, v140, v141
  v_mfma_f32_32x32x16_bf16 v[160:175], a[28:31], v[92:95], v[160:175]
  v_add_u32 v4, 65536, v4
  ds_read_b64_tr_b16 a[12:13], v4 offset:0
  ds_read_b64_tr_b16 a[14:15], v4 offset:512
  v_cvt_pk_bf16_f32 v135, v142, v143
  ds_write_b128 v198, v[132:135] offset:512
  s_waitcnt vmcnt(6)
  s_barrier
  s_waitcnt lgkmcnt(5)
  v_mfma_f32_32x32x16_bf16 v[160:175], a[0:3], v[96:99], v[160:175]
  ds_read_b64_tr_b16 a[16:17], v1 offset:8192
  ds_read_b64_tr_b16 a[18:19], v1 offset:8704
  v_mfma_f32_32x32x16_bf16 v[160:175], a[4:7], v[100:103], v[160:175]
  ds_read_b64_tr_b16 a[20:21], v2 offset:8192
  ds_read_b64_tr_b16 a[22:23], v2 offset:8704
  s_add_u32 m0, s93, 98304
  s_nop 0
  buffer_load_dwordx4 v7, s[40:43], s83 offen lds
  v_mfma_f32_16x16x32_bf16 v[184:187], v[176:179], a[0:3], v[184:187]
  s_waitcnt lgkmcnt(5)
  v_mfma_f32_32x32x16_bf16 v[160:175], a[8:11], v[104:107], v[160:175]
  ds_read_b64_tr_b16 a[24:25], v3 offset:8192
  ds_read_b64_tr_b16 a[26:27], v3 offset:8704
  v_mfma_f32_32x32x16_bf16 v[160:175], a[12:15], v[108:111], v[160:175]
  ds_read_b64_tr_b16 a[28:29], v4 offset:8192
  ds_read_b64_tr_b16 a[30:31], v4 offset:8704
  s_add_u32 m0, s93, 106496
  s_nop 0
  buffer_load_dwordx4 v6, s[40:43], s83 offen lds
  s_waitcnt lgkmcnt(4)
  v_mfma_f32_32x32x16_bf16 v[160:175], a[16:19], v[112:115], v[160:175]
  v_add_u32 v1, 4294836224, v1
  ds_read_b64_tr_b16 a[0:1], v1 offset:49152
  ds_read_b64_tr_b16 a[2:3], v1 offset:49664
  v_mfma_f32_32x32x16_bf16 v[160:175], a[20:23], v[116:119], v[160:175]
  v_add_u32 v2, 4294836224, v2
  ds_read_b64_tr_b16 a[4:5], v2 offset:49152
  ds_read_b64_tr_b16 a[6:7], v2 offset:49664
  v_mfma_f32_16x16x32_bf16 v[184:187], v[176:179], a[16:19], v[184:187]
  s_waitcnt lgkmcnt(4)
  v_mfma_f32_32x32x16_bf16 v[160:175], a[24:27], v[120:123], v[160:175]
  v_add_u32 v3, 4294836224, v3
  ds_read_b64_tr_b16 a[8:9], v3 offset:49152
  ds_read_b64_tr_b16 a[10:11], v3 offset:49664
  v_mfma_f32_32x32x16_bf16 v[160:175], a[28:31], v[124:127], v[160:175]
  v_add_u32 v4, 4294836224, v4
  ds_read_b64_tr_b16 a[12:13], v4 offset:49152
  ds_read_b64_tr_b16 a[14:15], v4 offset:49664
  s_cmp_lg_u32 s56, 0
  s_cbranch_scc1 LT1
  ds_write_b32 v12, v184
  s_waitcnt lgkmcnt(0)
  s_waitcnt vmcnt(6)
  s_barrier
  ds_read_b128 v[188:191], v11
  v_mfma_f32_32x32x16_bf16 v[128:143], a[0:3], v[16:19], 0
  ds_read_b64_tr_b16 a[16:17], v1 offset:57344
  ds_read_b64_tr_b16 a[18:19], v1 offset:57856
  s_add_u32 m0, s93, 131072
  s_nop 0
  buffer_load_dwordx4 v7, s[40:43], s84 offen lds
  v_mfma_f32_32x32x16_bf16 v[128:143], a[4:7], v[20:23], v[128:143]
  ds_read_b64_tr_b16 a[20:21], v2 offset:57344
  ds_read_b64_tr_b16 a[22:23], v2 offset:57856
  s_add_u32 m0, s93, 139264
  s_nop 0
  buffer_load_dwordx4 v6, s[40:43], s84 offen lds
  v_mfma_f32_16x16x32_bf16 v[184:187], v[176:179], a[0:3], 0
  s_waitcnt lgkmcnt(4)
  v_add_f32 v188, v188, v189
  v_add_f32 v190, v190, v191
  v_add_f32 v188, v188, v190
  v_and_b32 v189, 0xffff0000, v188
  v_sub_f32 v188, v188, v189
  v_mfma_f32_32x32x16_bf16 v[128:143], a[8:11], v[24:27], v[128:143]
  ds_read_b64_tr_b16 a[24:25], v3 offset:57344
  ds_read_b64_tr_b16 a[26:27], v3 offset:57856
  v_cvt_pk_bf16_f32 v182, v189, v188
  v_mfma_f32_32x32x16_bf16 v[128:143], a[12:15], v[28:31], v[128:143]
  ds_read_b64_tr_b16 a[28:29], v4 offset:57344
  ds_read_b64_tr_b16 a[30:31], v4 offset:57856
  v_mfma_f32_32x32x8_bf16 v[160:175], v[182:183], v[180:181], v[160:175]
  s_waitcnt lgkmcnt(4)
  v_mfma_f32_32x32x16_bf16 v[144:159], a[16:19], v[16:19], 0
  v_add_u32 v1, 65536, v1
  ds_read_b64_tr_b16 a[0:1], v1 offset:49152
  ds_read_b64_tr_b16 a[2:3], v1 offset:49664
  v_mfma_f32_32x32x16_bf16 v[144:159], a[20:23], v[20:23], v[144:159]
  v_add_u32 v2, 65536, v2
  ds_read_b64_tr_b16 a[4:5], v2 offset:49152
  ds_read_b64_tr_b16 a[6:7], v2 offset:49664
  v_mfma_f32_16x16x32_bf16 v[200:203], v[176:179], a[16:19], 0
  s_waitcnt lgkmcnt(4)
  v_mfma_f32_32x32x16_bf16 v[144:159], a[24:27], v[24:27], v[144:159]
  v_add_u32 v3, 65536, v3
  ds_read_b64_tr_b16 a[8:9], v3 offset:49152
  ds_read_b64_tr_b16 a[10:11], v3 offset:49664
  v_mul_f32 v160, v160, v10
  v_mfma_f32_32x32x16_bf16 v[144:159], a[28:31], v[28:31], v[144:159]
  v_add_u32 v4, 65536, v4
  ds_read_b64_tr_b16 a[12:13], v4 offset:49152
  ds_read_b64_tr_b16 a[14:15], v4 offset:49664
  v_mul_f32 v161, v161, v10
  v_mul_f32 v162, v162, v10
  s_waitcnt vmcnt(6)
  s_barrier
  s_waitcnt lgkmcnt(4)
  v_mfma_f32_32x32x16_bf16 v[128:143], a[0:3], v[32:35], v[128:143]
  ds_read_b64_tr_b16 a[16:17], v1 offset:57344
  ds_read_b64_tr_b16 a[18:19], v1 offset:57856
  s_add_u32 m0, s93, 49152
  s_nop 0
  buffer_load_dwordx4 v7, s[40:43], s85 offen lds
  v_mul_f32 v163, v163, v10
  v_mul_f32 v168, v168, v10
  v_mfma_f32_32x32x16_bf16 v[128:143], a[4:7], v[36:39], v[128:143]
  ds_read_b64_tr_b16 a[20:21], v2 offset:57344
  ds_read_b64_tr_b16 a[22:23], v2 offset:57856
  s_add_u32 m0, s93, 57344
  s_nop 0
  buffer_load_dwordx4 v6, s[40:43], s85 offen lds
  v_mfma_f32_16x16x32_bf16 v[184:187], v[176:179], a[0:3], v[184:187]
  v_mul_f32 v169, v169, v10
  v_mul_f32 v170, v170, v10
  s_waitcnt lgkmcnt(4)
  v_mfma_f32_32x32x16_bf16 v[128:143], a[8:11], v[40:43], v[128:143]
  ds_read_b64_tr_b16 a[24:25], v3 offset:57344
  ds_read_b64_tr_b16 a[26:27], v3 offset:57856
  v_mul_f32 v171, v171, v10
  v_cvt_pk_bf16_f32 v160, v160, v161
  v_mfma_f32_32x32x16_bf16 v[128:143], a[12:15], v[44:47], v[128:143]
  ds_read_b64_tr_b16 a[28:29], v4 offset:57344
  ds_read_b64_tr_b16 a[30:31], v4 offset:57856
  v_cvt_pk_bf16_f32 v161, v162, v163
  v_cvt_pk_bf16_f32 v162, v168, v169
  s_waitcnt lgkmcnt(4)
  v_mfma_f32_32x32x16_bf16 v[144:159], a[16:19], v[32:35], v[144:159]
  ds_read_b64_tr_b16 a[0:1], v1 offset:0
  ds_read_b64_tr_b16 a[2:3], v1 offset:512
  buffer_load_dwordx2 v[196:197], v13, s[60:63], s12 offen offset:0 sc1
  v_cvt_pk_bf16_f32 v163, v170, v171
  ds_write_b128 v198, v[160:163] offset:16384
  v_mfma_f32_32x32x16_bf16 v[144:159], a[20:23], v[36:39], v[144:159]
  ds_read_b64_tr_b16 a[4:5], v2 offset:0
  ds_read_b64_tr_b16 a[6:7], v2 offset:512
  v_mfma_f32_16x16x32_bf16 v[200:203], v[176:179], a[16:19], v[200:203]
  v_mul_f32 v164, v164, v10
  v_mul_f32 v165, v165, v10
  s_waitcnt lgkmcnt(5)
  v_mfma_f32_32x32x16_bf16 v[144:159], a[24:27], v[40:43], v[144:159]
  ds_read_b64_tr_b16 a[8:9], v3 offset:0
  ds_read_b64_tr_b16 a[10:11], v3 offset:512
  v_mul_f32 v166, v166, v10
  v_mul_f32 v167, v167, v10
  v_mfma_f32_32x32x16_bf16 v[144:159], a[28:31], v[44:47], v[144:159]
  ds_read_b64_tr_b16 a[12:13], v4 offset:0
  ds_read_b64_tr_b16 a[14:15], v4 offset:512
  v_mul_f32 v172, v172, v10
  s_waitcnt vmcnt(7)
  s_barrier
  s_waitcnt lgkmcnt(4)
  v_mfma_f32_32x32x16_bf16 v[128:143], a[0:3], v[48:51], v[128:143]
  ds_read_b64_tr_b16 a[16:17], v1 offset:8192
  ds_read_b64_tr_b16 a[18:19], v1 offset:8704
  v_mul_f32 v173, v173, v10
  v_mul_f32 v174, v174, v10
  v_mfma_f32_32x32x16_bf16 v[128:143], a[4:7], v[52:55], v[128:143]
  ds_read_b64_tr_b16 a[20:21], v2 offset:8192
  ds_read_b64_tr_b16 a[22:23], v2 offset:8704
  v_mfma_f32_16x16x32_bf16 v[184:187], v[176:179], a[0:3], v[184:187]
  v_mul_f32 v175, v175, v10
  v_cvt_pk_bf16_f32 v164, v164, v165
  s_waitcnt lgkmcnt(4)
  v_mfma_f32_32x32x16_bf16 v[128:143], a[8:11], v[56:59], v[128:143]
  ds_read_b64_tr_b16 a[24:25], v3 offset:8192
  ds_read_b64_tr_b16 a[26:27], v3 offset:8704
  v_cvt_pk_bf16_f32 v165, v166, v167
  v_cvt_pk_bf16_f32 v166, v172, v173
  v_mfma_f32_32x32x16_bf16 v[128:143], a[12:15], v[60:63], v[128:143]
  ds_read_b64_tr_b16 a[28:29], v4 offset:8192
  ds_read_b64_tr_b16 a[30:31], v4 offset:8704
  s_waitcnt vmcnt(0)
  v_cmp_ne_u64 vcc, v[196:197], v[14:15]
  s_cbranch_vccnz SLOW9
BACK9:
  v_cvt_pk_bf16_f32 v167, v174, v175
  ds_write_b128 v198, v[164:167] offset:16896
  s_waitcnt lgkmcnt(5)
  v_mfma_f32_32x32x16_bf16 v[144:159], a[16:19], v[48:51], v[144:159]
  ds_read_b64_tr_b16 a[0:1], v1 offset:16384
  ds_read_b64_tr_b16 a[2:3], v1 offset:16896
  s_add_u32 s101, s11, 1024
  buffer_load_dwordx4 a[32:35], v5, s[60:63], s101 offen sc1
  v_mfma_f32_32x32x16_bf16 v[144:159], a[20:23], v[52:55], v[144:159]
  ds_read_b64_tr_b16 a[4:5], v2 offset:16384
  ds_read_b64_tr_b16 a[6:7], v2 offset:16896
  v_mfma_f32_16x16x32_bf16 v[200:203], v[176:179], a[16:19], v[200:203]
  s_add_u32 s101, s10, 0
  buffer_load_dwordx4 a[36:39], v5, s[60:63], s101 offen sc1
  s_waitcnt lgkmcnt(5)
  v_mfma_f32_32x32x16_bf16 v[144:159], a[24:27], v[56:59], v[144:159]
  ds_read_b64_tr_b16 a[8:9], v3 offset:16384
  ds_read_b64_tr_b16 a[10:11], v3 offset:16896
  s_add_u32 s101, s10, 1024
  buffer_load_dwordx4 a[40:43], v5, s[60:63], s101 offen sc1
  v_mfma_f32_32x32x16_bf16 v[144:159], a[28:31], v[60:63], v[144:159]
  ds_read_b64_tr_b16 a[12:13], v4 offset:16384
  ds_read_b64_tr_b16 a[14:15], v4 offset:16896
  s_add_u32 s101, s11, 28672
  buffer_load_dwordx4 v[16:19], v5, s[60:63], s101 offen sc1
  s_barrier
  s_waitcnt lgkmcnt(4)
  v_mfma_f32_32x32x16_bf16 v[128:143], a[0:3], v[64:67], v[128:143]
  ds_read_b64_tr_b16 a[16:17], v1 offset:24576
  ds_read_b64_tr_b16 a[18:19], v1 offset:25088
  s_add_u32 s101, s10, 28672
  buffer_load_dwordx4 v[20:23], v5, s[60:63], s101 offen sc1
  v_mfma_f32_32x32x16_bf16 v[128:143], a[4:7], v[68:71], v[128:143]
  ds_read_b64_tr_b16 a[20:21], v2 offset:24576
  ds_read_b64_tr_b16 a[22:23], v2 offset:25088
  v_mfma_f32_16x16x32_bf16 v[184:187], v[176:179], a[0:3], v[184:187]
  s_add_u32 s101, s11, 29696
  buffer_load_dwordx4 v[24:27], v5, s[60:63], s101 offen sc1
  s_waitcnt lgkmcnt(4)
  v_mfma_f32_32x32x16_bf16 v[128:143], a[8:11], v[72:75], v[128:143]
  ds_read_b64_tr_b16 a[24:25], v3 offset:24576
  ds_read_b64_tr_b16 a[26:27], v3 offset:25088
  s_add_u32 s101, s10, 29696
  buffer_load_dwordx4 v[28:31], v5, s[60:63], s101 offen sc1
  v_mfma_f32_32x32x16_bf16 v[128:143], a[12:15], v[76:79], v[128:143]
  ds_read_b64_tr_b16 a[28:29], v4 offset:24576
  ds_read_b64_tr_b16 a[30:31], v4 offset:25088
  s_add_u32 s101, s11, 3072
  buffer_load_dwordx4 v[32:35], v5, s[60:63], s101 offen sc1
  s_waitcnt lgkmcnt(4)
  v_mfma_f32_32x32x16_bf16 v[144:159], a[16:19], v[64:67], v[144:159]
  ds_read_b64_tr_b16 a[0:1], v1 offset:32768
  ds_read_b64_tr_b16 a[2:3], v1 offset:33280
  s_add_u32 s101, s10, 2048
  buffer_load_dwordx4 v[36:39], v5, s[60:63], s101 offen sc1
  v_mfma_f32_32x32x16_bf16 v[144:159], a[20:23], v[68:71], v[144:159]
  ds_read_b64_tr_b16 a[4:5], v2 offset:32768
  ds_read_b64_tr_b16 a[6:7], v2 offset:33280
  v_mfma_f32_16x16x32_bf16 v[200:203], v[176:179], a[16:19], v[200:203]
  s_add_u32 s101, s10, 3072
  buffer_load_dwordx4 v[40:43], v5, s[60:63], s101 offen sc1
  s_waitcnt lgkmcnt(4)
  v_mfma_f32_32x32x16_bf16 v[144:159], a[24:27], v[72:75], v[144:159]
  ds_read_b64_tr_b16 a[8:9], v3 offset:32768
  ds_read_b64_tr_b16 a[10:11], v3 offset:33280
  s_add_u32 s101, s11, 30720
  buffer_load_dwordx4 v[44:47], v5, s[60:63], s101 offen sc1
  v_mfma_f32_32x32x16_bf16 v[144:159], a[28:31], v[76:79], v[144:159]
  ds_read_b64_tr_b16 a[12:13], v4 offset:32768
  ds_read_b64_tr_b16 a[14:15], v4 offset:33280
  s_add_u32 s101, s10, 30720
  buffer_load_dwordx4 v[48:51], v5, s[60:63], s101 offen sc1
  s_barrier
  s_waitcnt lgkmcnt(4)
  v_mfma_f32_32x32x16_bf16 v[128:143], a[0:3], v[80:83], v[128:143]
  ds_read_b64_tr_b16 a[16:17], v1 offset:40960
  ds_read_b64_tr_b16 a[18:19], v1 offset:41472
  s_add_u32 s101, s11, 31744
  buffer_load_dwordx4 v[52:55], v5, s[60:63], s101 offen sc1
  v_mfma_f32_32x32x16_bf16 v[128:143], a[4:7], v[84:87], v[128:143]
  ds_read_b64_tr_b16 a[20:21], v2 offset:40960
  ds_read_b64_tr_b16 a[22:23], v2 offset:41472
  v_mfma_f32_16x16x32_bf16 v[184:187], v[176:179], a[0:3], v[184:187]
  s_add_u32 s101, s10, 31744
  buffer_load_dwordx4 v[56:59], v5, s[60:63], s101 offen sc1
  s_waitcnt lgkmcnt(4)
  v_mfma_f32_32x32x16_bf16 v[128:143], a[8:11], v[88:91], v[128:143]
  ds_read_b64_tr_b16 a[24:25], v3 offset:40960
  ds_read_b64_tr_b16 a[26:27], v3 offset:41472
  s_add_u32 s101, s11, 5120
  buffer_load_dwordx4 v[60:63], v5, s[60:63], s101 offen sc1
  v_mfma_f32_32x32x16_bf16 v[128:143], a[12:15], v[92:95], v[128:143]
  ds_read_b64_tr_b16 a[28:29], v4 offset:40960
  ds_read_b64_tr_b16 a[30:31], v4 offset:41472
  s_add_u32 s101, s10, 4096
  buffer_load_dwordx4 v[64:67], v5, s[60:63], s101 offen sc1
  s_waitcnt lgkmcnt(4)
  v_mfma_f32_32x32x16_bf16 v[144:159], a[16:19], v[80:83], v[144:159]
  v_add_u32 v1, 65536, v1
  ds_read_b64_tr_b16 a[0:1], v1 offset:0
  ds_read_b64_tr_b16 a[2:3], v1 offset:512
  s_add_u32 s101, s10, 5120
  buffer_load_dwordx4 v[68:71], v5, s[60:63], s101 offen sc1
  v_mfma_f32_32x32x16_bf16 v[144:159], a[20:23], v[84:87], v[144:159]
  v_add_u32 v2, 65536, v2
  ds_read_b64_tr_b16 a[4:5], v2 offset:0
  ds_read_b64_tr_b16 a[6:7], v2 offset:512
  v_mfma_f32_16x16x32_bf16 v[200:203], v[176:179], a[16:19], v[200:203]
  s_add_u32 s101, s11, 32768
  buffer_load_dwordx4 v[72:75], v5, s[60:63], s101 offen sc1
  s_waitcnt lgkmcnt(4)
  v_mfma_f32_32x32x16_bf16 v[144:159], a[24:27], v[88:91], v[144:159]
  v_add_u32 v3, 65536, v3
  ds_read_b64_tr_b16 a[8:9], v3 offset:0
  ds_read_b64_tr_b16 a[10:11], v3 offset:512
  s_add_u32 s101, s10, 32768
  buffer_load_dwordx4 v[76:79], v5, s[60:63], s101 offen sc1
  v_mfma_f32_32x32x16_bf16 v[144:159], a[28:31], v[92:95], v[144:159]
  v_add_u32 v4, 65536, v4
  ds_read_b64_tr_b16 a[12:13], v4 offset:0
  ds_read_b64_tr_b16 a[14:15], v4 offset:512
  s_add_u32 s101, s11, 33792
  buffer_load_dwordx4 v[80:83], v5, s[60:63], s101 offen sc1
  s_barrier
  s_waitcnt lgkmcnt(4)
  v_mfma_f32_32x32x16_bf16 v[128:143], a[0:3], v[96:99], v[128:143]
  ds_read_b64_tr_b16 a[16:17], v1 offset:8192
  ds_read_b64_tr_b16 a[18:19], v1 offset:8704
  s_add_u32 s101, s10, 33792
  buffer_load_dwordx4 v[84:87], v5, s[60:63], s101 offen sc1
  v_mfma_f32_32x32x16_bf16 v[128:143], a[4:7], v[100:103], v[128:143]
  ds_read_b64_tr_b16 a[20:21], v2 offset:8192
  ds_read_b64_tr_b16 a[22:23], v2 offset:8704
  v_mfma_f32_16x16x32_bf16 v[184:187], v[176:179], a[0:3], v[184:187]
  s_add_u32 s101, s11, 7168
  buffer_load_dwordx4 v[88:91], v5, s[60:63], s101 offen sc1
  s_waitcnt lgkmcnt(4)
  v_mfma_f32_32x32x16_bf16 v[128:143], a[8:11], v[104:107], v[128:143]
  ds_read_b64_tr_b16 a[24:25], v3 offset:8192
  ds_read_b64_tr_b16 a[26:27], v3 offset:8704
  s_add_u32 s101, s10, 6144
  buffer_load_dwordx4 v[92:95], v5, s[60:63], s101 offen sc1
  v_mfma_f32_32x32x16_bf16 v[128:143], a[12:15], v[108:111], v[128:143]
  ds_read_b64_tr_b16 a[28:29], v4 offset:8192
  ds_read_b64_tr_b16 a[30:31], v4 offset:8704
  s_waitcnt lgkmcnt(4)
  v_mfma_f32_32x32x16_bf16 v[144:159], a[16:19], v[96:99], v[144:159]
  v_add_u32 v1, 4294836224, v1
  ds_read_b64_tr_b16 a[0:1], v1 offset:49152
  ds_read_b64_tr_b16 a[2:3], v1 offset:49664
  s_add_u32 s101, s10, 7168
  buffer_load_dwordx4 v[96:99], v5, s[60:63], s101 offen sc1
  v_mfma_f32_32x32x16_bf16 v[144:159], a[20:23], v[100:103], v[144:159]
  v_add_u32 v2, 4294836224, v2
  ds_read_b64_tr_b16 a[4:5], v2 offset:49152
  ds_read_b64_tr_b16 a[6:7], v2 offset:49664
  v_mfma_f32_16x16x32_bf16 v[200:203], v[176:179], a[16:19], v[200:203]
  s_add_u32 s101, s11, 34816
  buffer_load_dwordx4 v[100:103], v5, s[60:63], s101 offen sc1
  s_waitcnt lgkmcnt(4)
  v_mfma_f32_32x32x16_bf16 v[144:159], a[24:27], v[104:107], v[144:159]
  v_add_u32 v3, 4294836224, v3
  ds_read_b64_tr_b16 a[8:9], v3 offset:49152
  ds_read_b64_tr_b16 a[10:11], v3 offset:49664
  s_add_u32 s101, s10, 34816
  buffer_load_dwordx4 v[104:107], v5, s[60:63], s101 offen sc1
  v_mfma_f32_32x32x16_bf16 v[144:159], a[28:31], v[108:111], v[144:159]
  v_add_u32 v4, 4294836224, v4
  ds_read_b64_tr_b16 a[12:13], v4 offset:49152
  ds_read_b64_tr_b16 a[14:15], v4 offset:49664
  s_barrier
  s_waitcnt lgkmcnt(4)
  v_mfma_f32_32x32x16_bf16 v[128:143], a[0:3], v[112:115], v[128:143]
  ds_read_b64_tr_b16 a[16:17], v1 offset:57344
  ds_read_b64_tr_b16 a[18:19], v1 offset:57856
  v_mfma_f32_32x32x16_bf16 v[128:143], a[4:7], v[116:119], v[128:143]
  ds_read_b64_tr_b16 a[20:21], v2 offset:57344
  ds_read_b64_tr_b16 a[22:23], v2 offset:57856
  v_mfma_f32_16x16x32_bf16 v[184:187], v[176:179], a[0:3], v[184:187]
  s_waitcnt lgkmcnt(4)
  v_mfma_f32_32x32x16_bf16 v[128:143], a[8:11], v[120:123], v[128:143]
  ds_read_b64_tr_b16 a[24:25], v3 offset:57344
  ds_read_b64_tr_b16 a[26:27], v3 offset:57856
  v_mfma_f32_32x32x16_bf16 v[128:143], a[12:15], v[124:127], v[128:143]
  ds_read_b64_tr_b16 a[28:29], v4 offset:57344
  ds_read_b64_tr_b16 a[30:31], v4 offset:57856
  s_waitcnt lgkmcnt(4)
  v_mfma_f32_32x32x16_bf16 v[144:159], a[16:19], v[112:115], v[144:159]
  v_mfma_f32_32x32x16_bf16 v[144:159], a[20:23], v[116:119], v[144:159]
  v_mfma_f32_16x16x32_bf16 v[200:203], v[176:179], a[16:19], v[200:203]
  s_waitcnt lgkmcnt(0)
  v_mfma_f32_32x32x16_bf16 v[144:159], a[24:27], v[120:123], v[144:159]
  v_mfma_f32_32x32x16_bf16 v[144:159], a[28:31], v[124:127], v[144:159]
  s_nop 4
  ds_write_b32 v12, v200 offset:1024
  ds_write_b32 v12, v184
  s_waitcnt lgkmcnt(0)
  s_barrier
  ds_read_b128 v[188:191], v11
  ds_read_b128 v[192:195], v11 offset:1024
  s_waitcnt lgkmcnt(1)
  v_add_f32 v188, v188, v189
  v_add_f32 v190, v190, v191
  v_add_f32 v188, v188, v190
  v_and_b32 v189, 0xffff0000, v188
  v_sub_f32 v188, v188, v189
  v_cvt_pk_bf16_f32 v182, v189, v188
  s_nop 1
  v_mfma_f32_32x32x8_bf16 v[128:143], v[182:183], v[180:181], v[128:143]
  s_waitcnt lgkmcnt(0)
  v_mov_b32 v188, v192
  v_mov_b32 v189, v193
  v_mov_b32 v190, v194
  v_mov_b32 v191, v195
  v_add_f32 v188, v188, v189
  v_add_f32 v190, v190, v191
  v_add_f32 v188, v188, v190
  v_and_b32 v189, 0xffff0000, v188
  v_sub_f32 v188, v188, v189
  v_cvt_pk_bf16_f32 v182, v189, v188
  s_nop 1
  v_mfma_f32_32x32x8_bf16 v[144:159], v[182:183], v[180:181], v[144:159]
  v_mul_f32 v128, v128, v10
  v_mul_f32 v129, v129, v10
  v_mul_f32 v130, v130, v10
  v_mul_f32 v131, v131, v10
  v_mul_f32 v136, v136, v10
  v_mul_f32 v137, v137, v10
  v_mul_f32 v138, v138, v10
  v_mul_f32 v139, v139, v10
  v_cvt_pk_bf16_f32 v128, v128, v129
  v_cvt_pk_bf16_f32 v129, v130, v131
  v_cvt_pk_bf16_f32 v130, v136, v137
  v_cvt_pk_bf16_f32 v131, v138, v139
  ds_write_b128 v198, v[128:131] offset:32768
  v_mul_f32 v132, v132, v10
  v_mul_f32 v133, v133, v10
  v_mul_f32 v134, v134, v10
  v_mul_f32 v135, v135, v10
  v_mul_f32 v140, v140, v10
  v_mul_f32 v141, v141, v10
  v_mul_f32 v142, v142, v10
  v_mul_f32 v143, v143, v10
  v_cvt_pk_bf16_f32 v132, v132, v133
  v_cvt_pk_bf16_f32 v133, v134, v135
  v_cvt_pk_bf16_f32 v134, v140, v141
  v_cvt_pk_bf16_f32 v135, v142, v143
  ds_write_b128 v198, v[132:135] offset:33280
  v_mul_f32 v144, v144, v10
  v_mul_f32 v145, v145, v10
  v_mul_f32 v146, v146, v10
  v_mul_f32 v147, v147, v10
  v_mul_f32 v152, v152, v10
  v_mul_f32 v153, v153, v10
  v_mul_f32 v154, v154, v10
  v_mul_f32 v155, v155, v10
  v_cvt_pk_bf16_f32 v144, v144, v145
  v_cvt_pk_bf16_f32 v145, v146, v147
  v_cvt_pk_bf16_f32 v146, v152, v153
  v_cvt_pk_bf16_f32 v147, v154, v155
  ds_write_b128 v198, v[144:147] offset:49152
  v_mul_f32 v148, v148, v10
  v_mul_f32 v149, v149, v10
  v_mul_f32 v150, v150, v10
  v_mul_f32 v151, v151, v10
  v_mul_f32 v156, v156, v10
  v_mul_f32 v157, v157, v10
  v_mul_f32 v158, v158, v10
  v_mul_f32 v159, v159, v10
  v_cvt_pk_bf16_f32 v148, v148, v149
  v_cvt_pk_bf16_f32 v149, v150, v151
  v_cvt_pk_bf16_f32 v150, v156, v157
  v_cvt_pk_bf16_f32 v151, v158, v159
  ds_write_b128 v198, v[148:151] offset:49664
  s_waitcnt lgkmcnt(0)
  s_barrier
  s_mov_b32 s50, 0xffff
  s_mov_b32 s51, 0x0
  s_mov_b32 s52, 0xffffffff
  s_mov_b32 s53, 0x0
  s_mov_b32 s54, 0xffffffff
  s_mov_b32 s55, 0xffff
  s_mov_b32 s64, 0xffff0000
  s_mov_b32 s65, 0xffffffff
  s_mov_b32 s66, 0x0
  s_mov_b32 s67, 0xffffffff
  s_mov_b32 s72, 0x0
  s_mov_b32 s73, 0xffff0000
  s_mov_b32 s44, 0xaaaaaaaa
  s_mov_b32 s45, 0xaaaaaaaa
  s_mov_b32 s46, 0xfff0ffff
  s_mov_b32 s47, 0xf000ff00
  s_mov_b32 s48, 0xffc0fffc
  s_mov_b32 s49, 0xc000fc00
  v_mov_b32 v13, 0x0000ffff
  v_mov_b32 v7, 0xffff0000
  v_cndmask_b32 v13, v13, v7, s[44:45]
  v_cndmask_b32 v1, v13, 0, s[46:47]
  v_cndmask_b32 v3, 0, v13, s[46:47]
  v_cndmask_b32 v2, v13, 0, s[48:49]
  v_cndmask_b32 v4, 0, v13, s[48:49]
  v_mov_b32 v8, s96
  v_mov_b32 v9, s96
  v_mov_b32 v10, s96
  v_mov_b32 v11, s96
  v_mov_b32 v12, 1.0
  v_and_b32 v6, 15, v0
  v_lshlrev_b32 v6, 4, v6
  v_bfe_u32 v7, v0, 4, 1
  v_lshl_add_u32 v6, v7, 9, v6
  v_lshrrev_b32 v7, 5, v0
  v_lshl_add_u32 v6, v7, 10, v6
  s_mov_b32 s12, 0x3e8b97f6
  ds_read_b128 v[108:111], v199 offset:2048
  ds_read_b128 v[152:155], v199 offset:3072
  s_waitcnt lgkmcnt(1)
  s_waitcnt lgkmcnt(0)
  v_cndmask_b32 v110, 0, v110, s[54:55]
  v_cndmask_b32 v154, 0, v154, s[54:55]
  v_cndmask_b32 v111, 0, v111, s[54:55]
  v_cndmask_b32 v155, 0, v155, s[54:55]
  ds_read_b128 v[116:119], v199 offset:2048
  ds_read_b128 v[120:123], v199 offset:16384
  ds_read_b128 v[160:163], v199 offset:3072
  ds_read_b128 v[164:167], v199 offset:17408
  s_waitcnt vmcnt(25)
  v_mfma_f32_16x16x32_bf16 v[124:127], a[32:35], v[108:111], v[8:11]
  s_waitcnt vmcnt(24)
  v_mfma_f32_16x16x32_bf16 v[168:171], a[36:39], v[152:155], 0
  v_mfma_f32_16x16x32_bf16 v[128:131], a[36:39], v[108:111], 0
  s_waitcnt vmcnt(23)
  v_mfma_f32_16x16x32_bf16 v[172:175], a[40:43], v[152:155], 0
  s_nop 2
  v_cndmask_b32 v132, v124, v125, s[44:45]
  s_nop 0
  v_cndmask_b32 v176, v168, v169, s[44:45]
  v_cndmask_b32 v134, v128, v129, s[44:45]
  s_nop 0
  v_cndmask_b32 v178, v172, v173, s[44:45]
  v_cndmask_b32 v133, v126, v127, s[44:45]
  v_cndmask_b32 v177, v170, v171, s[44:45]
  v_cndmask_b32 v135, v130, v131, s[44:45]
  v_cndmask_b32 v179, v174, v175, s[44:45]
  v_cndmask_b32 v132, v132, v134, s[46:47]
  v_cndmask_b32 v176, v176, v178, s[46:47]
  v_cndmask_b32 v133, v133, v135, s[48:49]
  v_cndmask_b32 v177, v177, v179, s[48:49]
  v_max_f32 v134, v132, v133
  v_max_f32 v178, v176, v177
  v_mov_b32 v135, v134
  v_mov_b32 v179, v178
  s_nop 0
  v_permlane32_swap_b32 v134, v135
  v_permlane32_swap_b32 v178, v179
  v_max_f32 v134, v134, v135
  v_max_f32 v178, v178, v179
  v_mov_b32 v135, v134
  v_mov_b32 v179, v178
  s_nop 0
  v_permlane16_swap_b32 v134, v135
  v_permlane16_swap_b32 v178, v179
  v_max_f32 v134, v134, v135
  v_max_f32 v178, v178, v179
  v_sub_f32 v132, v132, v134
  v_sub_f32 v176, v176, v178
  v_sub_f32 v133, v133, v134
  v_sub_f32 v177, v177, v178
  v_mul_f32 v132, s12, v132
  v_mul_f32 v176, s12, v176
  v_mul_f32 v133, s12, v133
  v_mul_f32 v177, s12, v177
  v_exp_f32 v132, v132
  v_exp_f32 v176, v176
  v_exp_f32 v133, v133
  v_exp_f32 v177, v177
  v_add_f32 v134, v132, v133
  v_add_f32 v178, v176, v177
  s_nop 0
  v_mfma_f32_16x16x4_f32 v[124:127], v12, v134, 0
  v_mfma_f32_16x16x4_f32 v[168:171], v12, v178, 0
  s_nop 8
  v_rcp_f32 v135, v124
  v_rcp_f32 v179, v168
  v_mul_f32 v132, v132, v135
  v_mul_f32 v176, v176, v179
  v_mul_f32 v133, v133, v135
  v_mul_f32 v177, v177, v179
  v_cvt_pk_bf16_f32 v132, v132, v132
  v_cvt_pk_bf16_f32 v176, v176, v176
  v_cvt_pk_bf16_f32 v133, v133, v133
  v_cvt_pk_bf16_f32 v177, v177, v177
  v_and_b32 v128, v132, v1
  v_and_b32 v172, v176, v1
  v_and_b32 v129, v133, v2
  v_and_b32 v173, v177, v2
  v_and_b32 v130, v132, v3
  v_and_b32 v174, v176, v3
  v_and_b32 v131, v133, v4
  v_and_b32 v175, v177, v4
  s_waitcnt vmcnt(21)
  v_mfma_f32_16x16x32_bf16 v[136:139], v[18:21], v[128:131], 0
  v_mfma_f32_16x16x32_bf16 v[180:183], v[20:23], v[172:175], 0
  s_waitcnt vmcnt(19)
  v_mfma_f32_16x16x32_bf16 v[144:147], v[26:29], v[128:131], 0
  v_mfma_f32_16x16x32_bf16 v[188:191], v[28:31], v[172:175], 0
  s_nop 3
  v_cvt_pk_bf16_f32 v200, v136, v137
  v_cvt_pk_bf16_f32 v204, v180, v181
  v_cvt_pk_bf16_f32 v201, v138, v139
  v_cvt_pk_bf16_f32 v205, v182, v183
  s_waitcnt lgkmcnt(2)
  s_waitcnt lgkmcnt(0)
  v_mov_b32 v116, 0
  v_mov_b32 v160, 0
  v_mov_b32 v117, 0
  v_mov_b32 v161, 0
  v_cndmask_b32 v118, 0, v118, s[72:73]
  v_cndmask_b32 v162, 0, v162, s[72:73]
  v_cndmask_b32 v119, 0, v119, s[72:73]
  v_cndmask_b32 v163, 0, v163, s[72:73]
  v_cndmask_b32 v122, 0, v122, s[52:53]
  v_cndmask_b32 v166, 0, v166, s[52:53]
  v_cndmask_b32 v123, 0, v123, s[52:53]
  v_cndmask_b32 v167, 0, v167, s[52:53]
  ds_read_b128 v[108:111], v199 offset:16384
  ds_read_b128 v[112:115], v199 offset:18432
  ds_read_b128 v[152:155], v199 offset:17408
  ds_read_b128 v[156:159], v199 offset:19456
  v_mfma_f32_16x16x32_bf16 v[124:127], a[32:35], v[116:119], v[8:11]
  v_mfma_f32_16x16x32_bf16 v[168:171], a[36:39], v[160:163], 0
  v_mfma_f32_16x16x32_bf16 v[128:131], a[36:39], v[116:119], 0
  v_mfma_f32_16x16x32_bf16 v[172:175], a[40:43], v[160:163], 0
  s_waitcnt vmcnt(18)
  v_mfma_f32_16x16x32_bf16 v[124:127], v[32:35], v[120:123], v[124:127]
  s_waitcnt vmcnt(17)
  v_mfma_f32_16x16x32_bf16 v[168:171], v[36:39], v[164:167], v[168:171]
  v_mfma_f32_16x16x32_bf16 v[128:131], v[36:39], v[120:123], v[128:131]
  s_waitcnt vmcnt(16)
  v_mfma_f32_16x16x32_bf16 v[172:175], v[40:43], v[164:167], v[172:175]
  s_nop 2
  v_cndmask_b32 v132, v124, v125, s[44:45]
  s_nop 0
  v_cndmask_b32 v176, v168, v169, s[44:45]
  v_cndmask_b32 v134, v128, v129, s[44:45]
  s_nop 0
  v_cndmask_b32 v178, v172, v173, s[44:45]
  v_cndmask_b32 v133, v126, v127, s[44:45]
  v_cndmask_b32 v177, v170, v171, s[44:45]
  v_cndmask_b32 v135, v130, v131, s[44:45]
  v_cndmask_b32 v179, v174, v175, s[44:45]
  v_cndmask_b32 v132, v132, v134, s[46:47]
  v_cndmask_b32 v176, v176, v178, s[46:47]
  v_cndmask_b32 v133, v133, v135, s[48:49]
  v_cndmask_b32 v177, v177, v179, s[48:49]
  v_max_f32 v134, v132, v133
  v_max_f32 v178, v176, v177
  v_mov_b32 v135, v134
  v_mov_b32 v179, v178
  s_nop 0
  v_permlane32_swap_b32 v134, v135
  v_permlane32_swap_b32 v178, v179
  v_max_f32 v134, v134, v135
  v_max_f32 v178, v178, v179
  v_mov_b32 v135, v134
  v_mov_b32 v179, v178
  s_nop 0
  v_permlane16_swap_b32 v134, v135
  v_permlane16_swap_b32 v178, v179
  v_max_f32 v134, v134, v135
  v_max_f32 v178, v178, v179
  v_sub_f32 v132, v132, v134
  v_sub_f32 v176, v176, v178
  v_sub_f32 v133, v133, v134
  v_sub_f32 v177, v177, v178
  v_mul_f32 v132, s12, v132
  v_mul_f32 v176, s12, v176
  v_mul_f32 v133, s12, v133
  v_mul_f32 v177, s12, v177
  v_exp_f32 v132, v132
  v_exp_f32 v176, v176
  v_exp_f32 v133, v133
  v_exp_f32 v177, v177
  v_add_f32 v134, v132, v133
  v_add_f32 v178, v176, v177
  s_nop 0
  v_mfma_f32_16x16x4_f32 v[124:127], v12, v134, 0
  v_mfma_f32_16x16x4_f32 v[168:171], v12, v178, 0
  s_nop 8
  v_rcp_f32 v135, v124
  v_rcp_f32 v179, v168
  v_mul_f32 v132, v132, v135
  v_mul_f32 v176, v176, v179
  v_mul_f32 v133, v133, v135
  v_mul_f32 v177, v177, v179
  v_cvt_pk_bf16_f32 v132, v132, v132
  v_cvt_pk_bf16_f32 v176, v176, v176
  v_cvt_pk_bf16_f32 v133, v133, v133
  v_cvt_pk_bf16_f32 v177, v177, v177
  v_and_b32 v128, v132, v1
  v_and_b32 v172, v176, v1
  v_and_b32 v129, v133, v2
  v_and_b32 v173, v177, v2
  v_and_b32 v130, v132, v3
  v_and_b32 v174, v176, v3
  v_and_b32 v131, v133, v4
  v_and_b32 v175, v177, v4
  s_nop 0
  v_mfma_f32_16x16x32_bf16 v[136:139], v[26:29], v[128:131], 0
  v_mfma_f32_16x16x32_bf16 v[180:183], v[28:31], v[172:175], 0
  s_waitcnt vmcnt(14)
  v_mfma_f32_16x16x32_bf16 v[140:143], v[46:49], v[128:131], 0
  v_mfma_f32_16x16x32_bf16 v[184:187], v[48:51], v[172:175], 0
  s_waitcnt vmcnt(12)
  v_mfma_f32_16x16x32_bf16 v[148:151], v[54:57], v[128:131], 0
  v_mfma_f32_16x16x32_bf16 v[192:195], v[56:59], v[172:175], 0
  s_nop 0
  v_cndmask_b32 v136, v144, v136, s[72:73]
  v_cndmask_b32 v137, v145, v137, s[72:73]
  v_cndmask_b32 v138, v146, v138, s[72:73]
  v_cndmask_b32 v139, v147, v139, s[72:73]
  v_cndmask_b32 v180, v188, v180, s[72:73]
  v_cndmask_b32 v181, v189, v181, s[72:73]
  v_cndmask_b32 v182, v190, v182, s[72:73]
  v_cndmask_b32 v183, v191, v183, s[72:73]
  v_cvt_pk_bf16_f32 v202, v136, v137
  v_cvt_pk_bf16_f32 v206, v180, v181
  v_cvt_pk_bf16_f32 v203, v138, v139
  v_cvt_pk_bf16_f32 v207, v182, v183
  s_add_u32 s101, s59, 0
  buffer_store_dwordx4 v[200:203], v6, s[60:63], s101 offen offset:0 sc1
  s_add_u32 s101, s59, 0
  buffer_store_dwordx4 v[204:207], v6, s[60:63], s101 offen offset:256 sc1
  v_cvt_pk_bf16_f32 v200, v140, v141
  s_nop 0
  v_cvt_pk_bf16_f32 v204, v184, v185
  v_cvt_pk_bf16_f32 v201, v142, v143
  v_cvt_pk_bf16_f32 v205, v186, v187
  s_waitcnt lgkmcnt(2)
  s_waitcnt lgkmcnt(0)
  v_mov_b32 v108, 0
  v_mov_b32 v152, 0
  v_mov_b32 v109, 0
  v_mov_b32 v153, 0
  v_cndmask_b32 v110, 0, v110, s[66:67]
  v_cndmask_b32 v154, 0, v154, s[66:67]
  v_cndmask_b32 v111, 0, v111, s[66:67]
  v_cndmask_b32 v155, 0, v155, s[66:67]
  v_cndmask_b32 v114, 0, v114, s[50:51]
  v_cndmask_b32 v158, 0, v158, s[50:51]
  v_cndmask_b32 v115, 0, v115, s[50:51]
  v_cndmask_b32 v159, 0, v159, s[50:51]
  ds_read_b128 v[116:119], v199 offset:18432
  ds_read_b128 v[120:123], v199 offset:32768
  ds_read_b128 v[160:163], v199 offset:19456
  ds_read_b128 v[164:167], v199 offset:33792
  v_mfma_f32_16x16x32_bf16 v[124:127], v[32:35], v[108:111], v[8:11]
  v_mfma_f32_16x16x32_bf16 v[168:171], v[36:39], v[152:155], 0
  v_mfma_f32_16x16x32_bf16 v[128:131], v[36:39], v[108:111], 0
  v_mfma_f32_16x16x32_bf16 v[172:175], v[40:43], v[152:155], 0
  s_waitcnt vmcnt(13)
  v_mfma_f32_16x16x32_bf16 v[124:127], v[60:63], v[112:115], v[124:127]
  s_waitcnt vmcnt(12)
  v_mfma_f32_16x16x32_bf16 v[168:171], v[64:67], v[156:159], v[168:171]
  v_mfma_f32_16x16x32_bf16 v[128:131], v[64:67], v[112:115], v[128:131]
  s_waitcnt vmcnt(11)
  v_mfma_f32_16x16x32_bf16 v[172:175], v[68:71], v[156:159], v[172:175]
  s_nop 2
  v_cndmask_b32 v132, v124, v125, s[44:45]
  s_nop 0
  v_cndmask_b32 v176, v168, v169, s[44:45]
  v_cndmask_b32 v134, v128, v129, s[44:45]
  s_nop 0
  v_cndmask_b32 v178, v172, v173, s[44:45]
  v_cndmask_b32 v133, v126, v127, s[44:45]
  v_cndmask_b32 v177, v170, v171, s[44:45]
  v_cndmask_b32 v135, v130, v131, s[44:45]
  v_cndmask_b32 v179, v174, v175, s[44:45]
  v_cndmask_b32 v132, v132, v134, s[46:47]
  v_cndmask_b32 v176, v176, v178, s[46:47]
  v_cndmask_b32 v133, v133, v135, s[48:49]
  v_cndmask_b32 v177, v177, v179, s[48:49]
  v_max_f32 v134, v132, v133
  v_max_f32 v178, v176, v177
  v_mov_b32 v135, v134
  v_mov_b32 v179, v178
  s_nop 0
  v_permlane32_swap_b32 v134, v135
  v_permlane32_swap_b32 v178, v179
  v_max_f32 v134, v134, v135
  v_max_f32 v178, v178, v179
  v_mov_b32 v135, v134
  v_mov_b32 v179, v178
  s_nop 0
  v_permlane16_swap_b32 v134, v135
  v_permlane16_swap_b32 v178, v179
  v_max_f32 v134, v134, v135
  v_max_f32 v178, v178, v179
  v_sub_f32 v132, v132, v134
  v_sub_f32 v176, v176, v178
  v_sub_f32 v133, v133, v134
  v_sub_f32 v177, v177, v178
  v_mul_f32 v132, s12, v132
  v_mul_f32 v176, s12, v176
  v_mul_f32 v133, s12, v133
  v_mul_f32 v177, s12, v177
  v_exp_f32 v132, v132
  v_exp_f32 v176, v176
  v_exp_f32 v133, v133
  v_exp_f32 v177, v177
  v_add_f32 v134, v132, v133
  v_add_f32 v178, v176, v177
  s_nop 0
  v_mfma_f32_16x16x4_f32 v[124:127], v12, v134, 0
  v_mfma_f32_16x16x4_f32 v[168:171], v12, v178, 0
  s_nop 8
  v_rcp_f32 v135, v124
  v_rcp_f32 v179, v168
  v_mul_f32 v132, v132, v135
  v_mul_f32 v176, v176, v179
  v_mul_f32 v133, v133, v135
  v_mul_f32 v177, v177, v179
  v_cvt_pk_bf16_f32 v132, v132, v132
  v_cvt_pk_bf16_f32 v176, v176, v176
  v_cvt_pk_bf16_f32 v133, v133, v133
  v_cvt_pk_bf16_f32 v177, v177, v177
  v_and_b32 v128, v132, v1
  v_and_b32 v172, v176, v1
  v_and_b32 v129, v133, v2
  v_and_b32 v173, v177, v2
  v_and_b32 v130, v132, v3
  v_and_b32 v174, v176, v3
  v_and_b32 v131, v133, v4
  v_and_b32 v175, v177, v4
  s_nop 0
  v_mfma_f32_16x16x32_bf16 v[136:139], v[54:57], v[128:131], 0
  v_mfma_f32_16x16x32_bf16 v[180:183], v[56:59], v[172:175], 0
  s_waitcnt vmcnt(9)
  v_mfma_f32_16x16x32_bf16 v[140:143], v[74:77], v[128:131], 0
  v_mfma_f32_16x16x32_bf16 v[184:187], v[76:79], v[172:175], 0
  s_waitcnt vmcnt(7)
  v_mfma_f32_16x16x32_bf16 v[144:147], v[82:85], v[128:131], 0
  v_mfma_f32_16x16x32_bf16 v[188:191], v[84:87], v[172:175], 0
  s_nop 0
  v_cndmask_b32 v136, v148, v136, s[66:67]
  v_cndmask_b32 v137, v149, v137, s[66:67]
  v_cndmask_b32 v138, v150, v138, s[66:67]
  v_cndmask_b32 v139, v151, v139, s[66:67]
  v_cndmask_b32 v180, v192, v180, s[66:67]
  v_cndmask_b32 v181, v193, v181, s[66:67]
  v_cndmask_b32 v182, v194, v182, s[66:67]
  v_cndmask_b32 v183, v195, v183, s[66:67]
  v_cvt_pk_bf16_f32 v202, v136, v137
  v_cvt_pk_bf16_f32 v206, v180, v181
  v_cvt_pk_bf16_f32 v203, v138, v139
  v_cvt_pk_bf16_f32 v207, v182, v183
  s_add_u32 s101, s59, 2048
  buffer_store_dwordx4 v[200:203], v6, s[60:63], s101 offen offset:0 sc1
  s_add_u32 s101, s59, 2048
  buffer_store_dwordx4 v[204:207], v6, s[60:63], s101 offen offset:256 sc1
  v_cvt_pk_bf16_f32 v200, v140, v141
  s_nop 0
  v_cvt_pk_bf16_f32 v204, v184, v185
  v_cvt_pk_bf16_f32 v201, v142, v143
  v_cvt_pk_bf16_f32 v205, v186, v187
  s_waitcnt lgkmcnt(2)
  s_waitcnt lgkmcnt(0)
  v_mov_b32 v116, 0
  v_mov_b32 v160, 0
  v_mov_b32 v117, 0
  v_mov_b32 v161, 0
  v_cndmask_b32 v118, 0, v118, s[64:65]
  v_cndmask_b32 v162, 0, v162, s[64:65]
  v_cndmask_b32 v119, 0, v119, s[64:65]
  v_cndmask_b32 v163, 0, v163, s[64:65]
  v_mov_b32 v122, 0
  v_mov_b32 v166, 0
  v_mov_b32 v123, 0
  v_mov_b32 v167, 0
  v_mfma_f32_16x16x32_bf16 v[124:127], v[60:63], v[116:119], v[8:11]
  v_mfma_f32_16x16x32_bf16 v[168:171], v[64:67], v[160:163], 0
  v_mfma_f32_16x16x32_bf16 v[128:131], v[64:67], v[116:119], 0
  v_mfma_f32_16x16x32_bf16 v[172:175], v[68:71], v[160:163], 0
  s_waitcnt vmcnt(8)
  v_mfma_f32_16x16x32_bf16 v[124:127], v[88:91], v[120:123], v[124:127]
  s_waitcnt vmcnt(7)
  v_mfma_f32_16x16x32_bf16 v[168:171], v[92:95], v[164:167], v[168:171]
  v_mfma_f32_16x16x32_bf16 v[128:131], v[92:95], v[120:123], v[128:131]
  s_waitcnt vmcnt(6)
  v_mfma_f32_16x16x32_bf16 v[172:175], v[96:99], v[164:167], v[172:175]
  s_nop 2
  v_cndmask_b32 v132, v124, v125, s[44:45]
  s_nop 0
  v_cndmask_b32 v176, v168, v169, s[44:45]
  v_cndmask_b32 v134, v128, v129, s[44:45]
  s_nop 0
  v_cndmask_b32 v178, v172, v173, s[44:45]
  v_cndmask_b32 v133, v126, v127, s[44:45]
  v_cndmask_b32 v177, v170, v171, s[44:45]
  v_cndmask_b32 v135, v130, v131, s[44:45]
  v_cndmask_b32 v179, v174, v175, s[44:45]
  v_cndmask_b32 v132, v132, v134, s[46:47]
  v_cndmask_b32 v176, v176, v178, s[46:47]
  v_cndmask_b32 v133, v133, v135, s[48:49]
  v_cndmask_b32 v177, v177, v179, s[48:49]
  v_max_f32 v134, v132, v133
  v_max_f32 v178, v176, v177
  v_mov_b32 v135, v134
  v_mov_b32 v179, v178
  s_nop 0
  v_permlane32_swap_b32 v134, v135
  v_permlane32_swap_b32 v178, v179
  v_max_f32 v134, v134, v135
  v_max_f32 v178, v178, v179
  v_mov_b32 v135, v134
  v_mov_b32 v179, v178
  s_nop 0
  v_permlane16_swap_b32 v134, v135
  v_permlane16_swap_b32 v178, v179
  v_max_f32 v134, v134, v135
  v_max_f32 v178, v178, v179
  v_sub_f32 v132, v132, v134
  v_sub_f32 v176, v176, v178
  v_sub_f32 v133, v133, v134
  v_sub_f32 v177, v177, v178
  v_mul_f32 v132, s12, v132
  v_mul_f32 v176, s12, v176
  v_mul_f32 v133, s12, v133
  v_mul_f32 v177, s12, v177
  v_exp_f32 v132, v132
  v_exp_f32 v176, v176
  v_exp_f32 v133, v133
  v_exp_f32 v177, v177
  v_add_f32 v134, v132, v133
  v_add_f32 v178, v176, v177
  s_nop 0
  v_mfma_f32_16x16x4_f32 v[124:127], v12, v134, 0
  v_mfma_f32_16x16x4_f32 v[168:171], v12, v178, 0
  s_nop 8
  v_rcp_f32 v135, v124
  v_rcp_f32 v179, v168
  v_mul_f32 v132, v132, v135
  v_mul_f32 v176, v176, v179
  v_mul_f32 v133, v133, v135
  v_mul_f32 v177, v177, v179
  v_cvt_pk_bf16_f32 v132, v132, v132
  v_cvt_pk_bf16_f32 v176, v176, v176
  v_cvt_pk_bf16_f32 v133, v133, v133
  v_cvt_pk_bf16_f32 v177, v177, v177
  v_and_b32 v128, v132, v1
  v_and_b32 v172, v176, v1
  v_and_b32 v129, v133, v2
  v_and_b32 v173, v177, v2
  v_and_b32 v130, v132, v3
  v_and_b32 v174, v176, v3
  v_and_b32 v131, v133, v4
  v_and_b32 v175, v177, v4
  s_nop 0
  v_mfma_f32_16x16x32_bf16 v[136:139], v[82:85], v[128:131], 0
  v_mfma_f32_16x16x32_bf16 v[180:183], v[84:87], v[172:175], 0
  s_waitcnt vmcnt(4)
  v_mfma_f32_16x16x32_bf16 v[148:151], v[102:105], v[128:131], 0
  v_mfma_f32_16x16x32_bf16 v[192:195], v[104:107], v[172:175], 0
  s_nop 3
  v_cndmask_b32 v136, v144, v136, s[64:65]
  v_cndmask_b32 v137, v145, v137, s[64:65]
  v_cndmask_b32 v138, v146, v138, s[64:65]
  v_cndmask_b32 v139, v147, v139, s[64:65]
  v_cndmask_b32 v180, v188, v180, s[64:65]
  v_cndmask_b32 v181, v189, v181, s[64:65]
  v_cndmask_b32 v182, v190, v182, s[64:65]
  v_cndmask_b32 v183, v191, v183, s[64:65]
  v_cvt_pk_bf16_f32 v202, v136, v137
  v_cvt_pk_bf16_f32 v206, v180, v181
  v_cvt_pk_bf16_f32 v203, v138, v139
  v_cvt_pk_bf16_f32 v207, v182, v183
  s_add_u32 s101, s59, 4096
  buffer_store_dwordx4 v[200:203], v6, s[60:63], s101 offen offset:0 sc1
  s_add_u32 s101, s59, 4096
  buffer_store_dwordx4 v[204:207], v6, s[60:63], s101 offen offset:256 sc1
  v_cvt_pk_bf16_f32 v200, v148, v149
  s_nop 0
  v_cvt_pk_bf16_f32 v204, v192, v193
  v_cvt_pk_bf16_f32 v201, v150, v151
  v_cvt_pk_bf16_f32 v205, v194, v195
  s_add_u32 s101, s59, 6144
  buffer_store_dwordx2 v[200:201], v6, s[60:63], s101 offen offset:0 sc1
  s_add_u32 s101, s59, 6144
  buffer_store_dwordx2 v[204:205], v6, s[60:63], s101 offen offset:256 sc1
  s_waitcnt vmcnt(0)
  s_mov_b64 exec, 1
  buffer_store_dwordx2 v[14:15], off, s[60:63], s14 offset:3072 sc1
  s_mov_b64 exec, -1
  s_endpgm
LT1:
  s_nop 11
  ds_write_b32 v12, v184
  s_waitcnt lgkmcnt(0)
  s_waitcnt vmcnt(6)
  s_barrier
  ds_read_b128 v[188:191], v11
  v_mfma_f32_32x32x16_bf16 v[128:143], a[0:3], v[16:19], 0
  ds_read_b64_tr_b16 a[16:17], v1 offset:57344
  ds_read_b64_tr_b16 a[18:19], v1 offset:57856
  s_add_u32 m0, s93, 131072
  s_nop 0
  buffer_load_dwordx4 v7, s[40:43], s84 offen lds
  v_mfma_f32_32x32x16_bf16 v[128:143], a[4:7], v[20:23], v[128:143]
  ds_read_b64_tr_b16 a[20:21], v2 offset:57344
  ds_read_b64_tr_b16 a[22:23], v2 offset:57856
  s_add_u32 m0, s93, 139264
  s_nop 0
  buffer_load_dwordx4 v6, s[40:43], s84 offen lds
  v_mfma_f32_16x16x32_bf16 v[184:187], v[176:179], a[0:3], 0
  s_waitcnt lgkmcnt(4)
  v_add_f32 v188, v188, v189
  v_add_f32 v190, v190, v191
  v_add_f32 v188, v188, v190
  v_and_b32 v189, 0xffff0000, v188
  v_sub_f32 v188, v188, v189
  v_mfma_f32_32x32x16_bf16 v[128:143], a[8:11], v[24:27], v[128:143]
  ds_read_b64_tr_b16 a[24:25], v3 offset:57344
  ds_read_b64_tr_b16 a[26:27], v3 offset:57856
  v_cvt_pk_bf16_f32 v182, v189, v188
  v_mfma_f32_32x32x16_bf16 v[128:143], a[12:15], v[28:31], v[128:143]
  ds_read_b64_tr_b16 a[28:29], v4 offset:57344
  ds_read_b64_tr_b16 a[30:31], v4 offset:57856
  v_mfma_f32_32x32x8_bf16 v[160:175], v[182:183], v[180:181], v[160:175]
  s_waitcnt lgkmcnt(4)
  v_mfma_f32_32x32x16_bf16 v[144:159], a[16:19], v[16:19], 0
  v_add_u32 v1, 65536, v1
  ds_read_b64_tr_b16 a[0:1], v1 offset:49152
  ds_read_b64_tr_b16 a[2:3], v1 offset:49664
  v_mfma_f32_32x32x16_bf16 v[144:159], a[20:23], v[20:23], v[144:159]
  v_add_u32 v2, 65536, v2
  ds_read_b64_tr_b16 a[4:5], v2 offset:49152
  ds_read_b64_tr_b16 a[6:7], v2 offset:49664
  v_mfma_f32_16x16x32_bf16 v[200:203], v[176:179], a[16:19], 0
  s_waitcnt lgkmcnt(4)
  v_mfma_f32_32x32x16_bf16 v[144:159], a[24:27], v[24:27], v[144:159]
  v_add_u32 v3, 65536, v3
  ds_read_b64_tr_b16 a[8:9], v3 offset:49152
  ds_read_b64_tr_b16 a[10:11], v3 offset:49664
  v_mul_f32 v160, v160, v10
  v_mfma_f32_32x32x16_bf16 v[144:159], a[28:31], v[28:31], v[144:159]
  v_add_u32 v4, 65536, v4
  ds_read_b64_tr_b16 a[12:13], v4 offset:49152
  ds_read_b64_tr_b16 a[14:15], v4 offset:49664
  v_mul_f32 v161, v161, v10
  v_mul_f32 v162, v162, v10
  s_waitcnt vmcnt(6)
  s_barrier
  s_waitcnt lgkmcnt(4)
  v_mfma_f32_32x32x16_bf16 v[128:143], a[0:3], v[32:35], v[128:143]
  ds_read_b64_tr_b16 a[16:17], v1 offset:57344
  ds_read_b64_tr_b16 a[18:19], v1 offset:57856
  s_add_u32 m0, s93, 49152
  s_nop 0
  buffer_load_dwordx4 v7, s[40:43], s85 offen lds
  v_mul_f32 v163, v163, v10
  v_mul_f32 v168, v168, v10
  v_mfma_f32_32x32x16_bf16 v[128:143], a[4:7], v[36:39], v[128:143]
  ds_read_b64_tr_b16 a[20:21], v2 offset:57344
  ds_read_b64_tr_b16 a[22:23], v2 offset:57856
  s_add_u32 m0, s93, 57344
  s_nop 0
  buffer_load_dwordx4 v6, s[40:43], s85 offen lds
  v_mfma_f32_16x16x32_bf16 v[184:187], v[176:179], a[0:3], v[184:187]
  v_mul_f32 v169, v169, v10
  v_mul_f32 v170, v170, v10
  s_waitcnt lgkmcnt(4)
  v_mfma_f32_32x32x16_bf16 v[128:143], a[8:11], v[40:43], v[128:143]
  ds_read_b64_tr_b16 a[24:25], v3 offset:57344
  ds_read_b64_tr_b16 a[26:27], v3 offset:57856
  v_mul_f32 v171, v171, v10
  v_cvt_pk_bf16_f32 v160, v160, v161
  v_mfma_f32_32x32x16_bf16 v[128:143], a[12:15], v[44:47], v[128:143]
  ds_read_b64_tr_b16 a[28:29], v4 offset:57344
  ds_read_b64_tr_b16 a[30:31], v4 offset:57856
  v_cvt_pk_bf16_f32 v161, v162, v163
  v_cvt_pk_bf16_f32 v162, v168, v169
  s_waitcnt lgkmcnt(4)
  v_mfma_f32_32x32x16_bf16 v[144:159], a[16:19], v[32:35], v[144:159]
  ds_read_b64_tr_b16 a[0:1], v1 offset:0
  ds_read_b64_tr_b16 a[2:3], v1 offset:512
  buffer_load_dwordx2 v[196:197], v13, s[60:63], s12 offen offset:0 sc1
  v_cvt_pk_bf16_f32 v163, v170, v171
  ds_write_b128 v198, v[160:163] offset:16384
  v_mfma_f32_32x32x16_bf16 v[144:159], a[20:23], v[36:39], v[144:159]
  ds_read_b64_tr_b16 a[4:5], v2 offset:0
  ds_read_b64_tr_b16 a[6:7], v2 offset:512
  v_mfma_f32_16x16x32_bf16 v[200:203], v[176:179], a[16:19], v[200:203]
  v_mul_f32 v164, v164, v10
  v_mul_f32 v165, v165, v10
  s_waitcnt lgkmcnt(5)
  v_mfma_f32_32x32x16_bf16 v[144:159], a[24:27], v[40:43], v[144:159]
  ds_read_b64_tr_b16 a[8:9], v3 offset:0
  ds_read_b64_tr_b16 a[10:11], v3 offset:512
  v_mul_f32 v166, v166, v10
  v_mul_f32 v167, v167, v10
  v_mfma_f32_32x32x16_bf16 v[144:159], a[28:31], v[44:47], v[144:159]
  ds_read_b64_tr_b16 a[12:13], v4 offset:0
  ds_read_b64_tr_b16 a[14:15], v4 offset:512
  v_mul_f32 v172, v172, v10
  s_waitcnt vmcnt(7)
  s_barrier
  s_waitcnt lgkmcnt(4)
  v_mfma_f32_32x32x16_bf16 v[128:143], a[0:3], v[48:51], v[128:143]
  ds_read_b64_tr_b16 a[16:17], v1 offset:8192
  ds_read_b64_tr_b16 a[18:19], v1 offset:8704
  v_mul_f32 v173, v173, v10
  v_mul_f32 v174, v174, v10
  v_mfma_f32_32x32x16_bf16 v[128:143], a[4:7], v[52:55], v[128:143]
  ds_read_b64_tr_b16 a[20:21], v2 offset:8192
  ds_read_b64_tr_b16 a[22:23], v2 offset:8704
  v_mfma_f32_16x16x32_bf16 v[184:187], v[176:179], a[0:3], v[184:187]
  v_mul_f32 v175, v175, v10
  v_cvt_pk_bf16_f32 v164, v164, v165
  s_waitcnt lgkmcnt(4)
  v_mfma_f32_32x32x16_bf16 v[128:143], a[8:11], v[56:59], v[128:143]
  ds_read_b64_tr_b16 a[24:25], v3 offset:8192
  ds_read_b64_tr_b16 a[26:27], v3 offset:8704
  v_cvt_pk_bf16_f32 v165, v166, v167
  v_cvt_pk_bf16_f32 v166, v172, v173
  v_mfma_f32_32x32x16_bf16 v[128:143], a[12:15], v[60:63], v[128:143]
  ds_read_b64_tr_b16 a[28:29], v4 offset:8192
  ds_read_b64_tr_b16 a[30:31], v4 offset:8704
  s_waitcnt vmcnt(0)
  v_cmp_ne_u64 vcc, v[196:197], v[14:15]
  s_cbranch_vccnz SLOW10
BACK10:
  v_cvt_pk_bf16_f32 v167, v174, v175
  ds_write_b128 v198, v[164:167] offset:16896
  s_waitcnt lgkmcnt(5)
  v_mfma_f32_32x32x16_bf16 v[144:159], a[16:19], v[48:51], v[144:159]
  ds_read_b64_tr_b16 a[0:1], v1 offset:16384
  ds_read_b64_tr_b16 a[2:3], v1 offset:16896
  s_add_u32 s101, s11, 7168
  buffer_load_dwordx4 a[32:35], v5, s[60:63], s101 offen sc1
  v_mfma_f32_32x32x16_bf16 v[144:159], a[20:23], v[52:55], v[144:159]
  ds_read_b64_tr_b16 a[4:5], v2 offset:16384
  ds_read_b64_tr_b16 a[6:7], v2 offset:16896
  v_mfma_f32_16x16x32_bf16 v[200:203], v[176:179], a[16:19], v[200:203]
  s_add_u32 s101, s10, 6144
  buffer_load_dwordx4 a[36:39], v5, s[60:63], s101 offen sc1
  s_waitcnt lgkmcnt(5)
  v_mfma_f32_32x32x16_bf16 v[144:159], a[24:27], v[56:59], v[144:159]
  ds_read_b64_tr_b16 a[8:9], v3 offset:16384
  ds_read_b64_tr_b16 a[10:11], v3 offset:16896
  s_add_u32 s101, s10, 7168
  buffer_load_dwordx4 a[40:43], v5, s[60:63], s101 offen sc1
  v_mfma_f32_32x32x16_bf16 v[144:159], a[28:31], v[60:63], v[144:159]
  ds_read_b64_tr_b16 a[12:13], v4 offset:16384
  ds_read_b64_tr_b16 a[14:15], v4 offset:16896
  s_add_u32 s101, s11, 35840
  buffer_load_dwordx4 v[16:19], v5, s[60:63], s101 offen sc1
  s_barrier
  s_waitcnt lgkmcnt(4)
  v_mfma_f32_32x32x16_bf16 v[128:143], a[0:3], v[64:67], v[128:143]
  ds_read_b64_tr_b16 a[16:17], v1 offset:24576
  ds_read_b64_tr_b16 a[18:19], v1 offset:25088
  s_add_u32 s101, s10, 35840
  buffer_load_dwordx4 v[20:23], v5, s[60:63], s101 offen sc1
  v_mfma_f32_32x32x16_bf16 v[128:143], a[4:7], v[68:71], v[128:143]
  ds_read_b64_tr_b16 a[20:21], v2 offset:24576
  ds_read_b64_tr_b16 a[22:23], v2 offset:25088
  v_mfma_f32_16x16x32_bf16 v[184:187], v[176:179], a[0:3], v[184:187]
  s_add_u32 s101, s11, 9216
  buffer_load_dwordx4 v[24:27], v5, s[60:63], s101 offen sc1
  s_waitcnt lgkmcnt(4)
  v_mfma_f32_32x32x16_bf16 v[128:143], a[8:11], v[72:75], v[128:143]
  ds_read_b64_tr_b16 a[24:25], v3 offset:24576
  ds_read_b64_tr_b16 a[26:27], v3 offset:25088
  s_add_u32 s101, s10, 8192
  buffer_load_dwordx4 v[28:31], v5, s[60:63], s101 offen sc1
  v_mfma_f32_32x32x16_bf16 v[128:143], a[12:15], v[76:79], v[128:143]
  ds_read_b64_tr_b16 a[28:29], v4 offset:24576
  ds_read_b64_tr_b16 a[30:31], v4 offset:25088
  s_add_u32 s101, s10, 9216
  buffer_load_dwordx4 v[32:35], v5, s[60:63], s101 offen sc1
  s_waitcnt lgkmcnt(4)
  v_mfma_f32_32x32x16_bf16 v[144:159], a[16:19], v[64:67], v[144:159]
  ds_read_b64_tr_b16 a[0:1], v1 offset:32768
  ds_read_b64_tr_b16 a[2:3], v1 offset:33280
  s_add_u32 s101, s11, 36864
  buffer_load_dwordx4 v[36:39], v5, s[60:63], s101 offen sc1
  v_mfma_f32_32x32x16_bf16 v[144:159], a[20:23], v[68:71], v[144:159]
  ds_read_b64_tr_b16 a[4:5], v2 offset:32768
  ds_read_b64_tr_b16 a[6:7], v2 offset:33280
  v_mfma_f32_16x16x32_bf16 v[200:203], v[176:179], a[16:19], v[200:203]
  s_add_u32 s101, s10, 36864
  buffer_load_dwordx4 v[40:43], v5, s[60:63], s101 offen sc1
  s_waitcnt lgkmcnt(4)
  v_mfma_f32_32x32x16_bf16 v[144:159], a[24:27], v[72:75], v[144:159]
  ds_read_b64_tr_b16 a[8:9], v3 offset:32768
  ds_read_b64_tr_b16 a[10:11], v3 offset:33280
  s_add_u32 s101, s11, 37888
  buffer_load_dwordx4 v[44:47], v5, s[60:63], s101 offen sc1
  v_mfma_f32_32x32x16_bf16 v[144:159], a[28:31], v[76:79], v[144:159]
  ds_read_b64_tr_b16 a[12:13], v4 offset:32768
  ds_read_b64_tr_b16 a[14:15], v4 offset:33280
  s_add_u32 s101, s10, 37888
  buffer_load_dwordx4 v[48:51], v5, s[60:63], s101 offen sc1
  s_barrier
  s_waitcnt lgkmcnt(4)
  v_mfma_f32_32x32x16_bf16 v[128:143], a[0:3], v[80:83], v[128:143]
  ds_read_b64_tr_b16 a[16:17], v1 offset:40960
  ds_read_b64_tr_b16 a[18:19], v1 offset:41472
  s_add_u32 s101, s11, 11264
  buffer_load_dwordx4 v[52:55], v5, s[60:63], s101 offen sc1
  v_mfma_f32_32x32x16_bf16 v[128:143], a[4:7], v[84:87], v[128:143]
  ds_read_b64_tr_b16 a[20:21], v2 offset:40960
  ds_read_b64_tr_b16 a[22:23], v2 offset:41472
  v_mfma_f32_16x16x32_bf16 v[184:187], v[176:179], a[0:3], v[184:187]
  s_add_u32 s101, s10, 10240
  buffer_load_dwordx4 v[56:59], v5, s[60:63], s101 offen sc1
  s_waitcnt lgkmcnt(4)
  v_mfma_f32_32x32x16_bf16 v[128:143], a[8:11], v[88:91], v[128:143]
  ds_read_b64_tr_b16 a[24:25], v3 offset:40960
  ds_read_b64_tr_b16 a[26:27], v3 offset:41472
  s_add_u32 s101, s10, 11264
  buffer_load_dwordx4 v[60:63], v5, s[60:63], s101 offen sc1
  v_mfma_f32_32x32x16_bf16 v[128:143], a[12:15], v[92:95], v[128:143]
  ds_read_b64_tr_b16 a[28:29], v4 offset:40960
  ds_read_b64_tr_b16 a[30:31], v4 offset:41472
  s_add_u32 s101, s11, 38912
  buffer_load_dwordx4 v[64:67], v5, s[60:63], s101 offen sc1
  s_waitcnt lgkmcnt(4)
  v_mfma_f32_32x32x16_bf16 v[144:159], a[16:19], v[80:83], v[144:159]
  v_add_u32 v1, 65536, v1
  ds_read_b64_tr_b16 a[0:1], v1 offset:0
  ds_read_b64_tr_b16 a[2:3], v1 offset:512
  s_add_u32 s101, s10, 38912
  buffer_load_dwordx4 v[68:71], v5, s[60:63], s101 offen sc1
  v_mfma_f32_32x32x16_bf16 v[144:159], a[20:23], v[84:87], v[144:159]
  v_add_u32 v2, 65536, v2
  ds_read_b64_tr_b16 a[4:5], v2 offset:0
  ds_read_b64_tr_b16 a[6:7], v2 offset:512
  v_mfma_f32_16x16x32_bf16 v[200:203], v[176:179], a[16:19], v[200:203]
  s_add_u32 s101, s11, 39936
  buffer_load_dwordx4 v[72:75], v5, s[60:63], s101 offen sc1
  s_waitcnt lgkmcnt(4)
  v_mfma_f32_32x32x16_bf16 v[144:159], a[24:27], v[88:91], v[144:159]
  v_add_u32 v3, 65536, v3
  ds_read_b64_tr_b16 a[8:9], v3 offset:0
  ds_read_b64_tr_b16 a[10:11], v3 offset:512
  s_add_u32 s101, s10, 39936
  buffer_load_dwordx4 v[76:79], v5, s[60:63], s101 offen sc1
  v_mfma_f32_32x32x16_bf16 v[144:159], a[28:31], v[92:95], v[144:159]
  v_add_u32 v4, 65536, v4
  ds_read_b64_tr_b16 a[12:13], v4 offset:0
  ds_read_b64_tr_b16 a[14:15], v4 offset:512
  s_add_u32 s101, s11, 13312
  buffer_load_dwordx4 v[80:83], v5, s[60:63], s101 offen sc1
  s_barrier
  s_waitcnt lgkmcnt(4)
  v_mfma_f32_32x32x16_bf16 v[128:143], a[0:3], v[96:99], v[128:143]
  ds_read_b64_tr_b16 a[16:17], v1 offset:8192
  ds_read_b64_tr_b16 a[18:19], v1 offset:8704
  s_add_u32 s101, s10, 12288
  buffer_load_dwordx4 v[84:87], v5, s[60:63], s101 offen sc1
  v_mfma_f32_32x32x16_bf16 v[128:143], a[4:7], v[100:103], v[128:143]
  ds_read_b64_tr_b16 a[20:21], v2 offset:8192
  ds_read_b64_tr_b16 a[22:23], v2 offset:8704
  v_mfma_f32_16x16x32_bf16 v[184:187], v[176:179], a[0:3], v[184:187]
  s_add_u32 s101, s10, 13312
  buffer_load_dwordx4 v[88:91], v5, s[60:63], s101 offen sc1
  s_waitcnt lgkmcnt(4)
  v_mfma_f32_32x32x16_bf16 v[128:143], a[8:11], v[104:107], v[128:143]
  ds_read_b64_tr_b16 a[24:25], v3 offset:8192
  ds_read_b64_tr_b16 a[26:27], v3 offset:8704
  s_add_u32 s101, s11, 40960
  buffer_load_dwordx4 v[92:95], v5, s[60:63], s101 offen sc1
  v_mfma_f32_32x32x16_bf16 v[128:143], a[12:15], v[108:111], v[128:143]
  ds_read_b64_tr_b16 a[28:29], v4 offset:8192
  ds_read_b64_tr_b16 a[30:31], v4 offset:8704
  s_waitcnt lgkmcnt(4)
  v_mfma_f32_32x32x16_bf16 v[144:159], a[16:19], v[96:99], v[144:159]
  v_add_u32 v1, 4294836224, v1
  ds_read_b64_tr_b16 a[0:1], v1 offset:49152
  ds_read_b64_tr_b16 a[2:3], v1 offset:49664
  s_add_u32 s101, s10, 40960
  buffer_load_dwordx4 v[96:99], v5, s[60:63], s101 offen sc1
  v_mfma_f32_32x32x16_bf16 v[144:159], a[20:23], v[100:103], v[144:159]
  v_add_u32 v2, 4294836224, v2
  ds_read_b64_tr_b16 a[4:5], v2 offset:49152
  ds_read_b64_tr_b16 a[6:7], v2 offset:49664
  v_mfma_f32_16x16x32_bf16 v[200:203], v[176:179], a[16:19], v[200:203]
  s_add_u32 s101, s11, 41984
  buffer_load_dwordx4 v[100:103], v5, s[60:63], s101 offen sc1
  s_waitcnt lgkmcnt(4)
  v_mfma_f32_32x32x16_bf16 v[144:159], a[24:27], v[104:107], v[144:159]
  v_add_u32 v3, 4294836224, v3
  ds_read_b64_tr_b16 a[8:9], v3 offset:49152
  ds_read_b64_tr_b16 a[10:11], v3 offset:49664
  s_add_u32 s101, s10, 41984
  buffer_load_dwordx4 v[104:107], v5, s[60:63], s101 offen sc1
  v_mfma_f32_32x32x16_bf16 v[144:159], a[28:31], v[108:111], v[144:159]
  v_add_u32 v4, 4294836224, v4
  ds_read_b64_tr_b16 a[12:13], v4 offset:49152
  ds_read_b64_tr_b16 a[14:15], v4 offset:49664
  s_barrier
  s_waitcnt lgkmcnt(4)
  v_mfma_f32_32x32x16_bf16 v[128:143], a[0:3], v[112:115], v[128:143]
  ds_read_b64_tr_b16 a[16:17], v1 offset:57344
  ds_read_b64_tr_b16 a[18:19], v1 offset:57856
  v_mfma_f32_32x32x16_bf16 v[128:143], a[4:7], v[116:119], v[128:143]
  ds_read_b64_tr_b16 a[20:21], v2 offset:57344
  ds_read_b64_tr_b16 a[22:23], v2 offset:57856
  v_mfma_f32_16x16x32_bf16 v[184:187], v[176:179], a[0:3], v[184:187]
  s_waitcnt lgkmcnt(4)
  v_mfma_f32_32x32x16_bf16 v[128:143], a[8:11], v[120:123], v[128:143]
  ds_read_b64_tr_b16 a[24:25], v3 offset:57344
  ds_read_b64_tr_b16 a[26:27], v3 offset:57856
  v_mfma_f32_32x32x16_bf16 v[128:143], a[12:15], v[124:127], v[128:143]
  ds_read_b64_tr_b16 a[28:29], v4 offset:57344
  ds_read_b64_tr_b16 a[30:31], v4 offset:57856
  s_waitcnt lgkmcnt(4)
  v_mfma_f32_32x32x16_bf16 v[144:159], a[16:19], v[112:115], v[144:159]
  v_mfma_f32_32x32x16_bf16 v[144:159], a[20:23], v[116:119], v[144:159]
  v_mfma_f32_16x16x32_bf16 v[200:203], v[176:179], a[16:19], v[200:203]
  s_waitcnt lgkmcnt(0)
  v_mfma_f32_32x32x16_bf16 v[144:159], a[24:27], v[120:123], v[144:159]
  v_mfma_f32_32x32x16_bf16 v[144:159], a[28:31], v[124:127], v[144:159]
  s_nop 4
  ds_write_b32 v12, v200 offset:1024
  ds_write_b32 v12, v184
  s_waitcnt lgkmcnt(0)
  s_barrier
  ds_read_b128 v[188:191], v11
  ds_read_b128 v[192:195], v11 offset:1024
  s_waitcnt lgkmcnt(1)
  v_add_f32 v188, v188, v189
  v_add_f32 v190, v190, v191
  v_add_f32 v188, v188, v190
  v_and_b32 v189, 0xffff0000, v188
  v_sub_f32 v188, v188, v189
  v_cvt_pk_bf16_f32 v182, v189, v188
  s_nop 1
  v_mfma_f32_32x32x8_bf16 v[128:143], v[182:183], v[180:181], v[128:143]
  s_waitcnt lgkmcnt(0)
  v_mov_b32 v188, v192
  v_mov_b32 v189, v193
  v_mov_b32 v190, v194
  v_mov_b32 v191, v195
  v_add_f32 v188, v188, v189
  v_add_f32 v190, v190, v191
  v_add_f32 v188, v188, v190
  v_and_b32 v189, 0xffff0000, v188
  v_sub_f32 v188, v188, v189
  v_cvt_pk_bf16_f32 v182, v189, v188
  s_nop 1
  v_mfma_f32_32x32x8_bf16 v[144:159], v[182:183], v[180:181], v[144:159]
  v_mul_f32 v128, v128, v10
  v_mul_f32 v129, v129, v10
  v_mul_f32 v130, v130, v10
  v_mul_f32 v131, v131, v10
  v_mul_f32 v136, v136, v10
  v_mul_f32 v137, v137, v10
  v_mul_f32 v138, v138, v10
  v_mul_f32 v139, v139, v10
  v_cvt_pk_bf16_f32 v128, v128, v129
  v_cvt_pk_bf16_f32 v129, v130, v131
  v_cvt_pk_bf16_f32 v130, v136, v137
  v_cvt_pk_bf16_f32 v131, v138, v139
  ds_write_b128 v198, v[128:131] offset:32768
  v_mul_f32 v132, v132, v10
  v_mul_f32 v133, v133, v10
  v_mul_f32 v134, v134, v10
  v_mul_f32 v135, v135, v10
  v_mul_f32 v140, v140, v10
  v_mul_f32 v141, v141, v10
  v_mul_f32 v142, v142, v10
  v_mul_f32 v143, v143, v10
  v_cvt_pk_bf16_f32 v132, v132, v133
  v_cvt_pk_bf16_f32 v133, v134, v135
  v_cvt_pk_bf16_f32 v134, v140, v141
  v_cvt_pk_bf16_f32 v135, v142, v143
  ds_write_b128 v198, v[132:135] offset:33280
  v_mul_f32 v144, v144, v10
  v_mul_f32 v145, v145, v10
  v_mul_f32 v146, v146, v10
  v_mul_f32 v147, v147, v10
  v_mul_f32 v152, v152, v10
  v_mul_f32 v153, v153, v10
  v_mul_f32 v154, v154, v10
  v_mul_f32 v155, v155, v10
  v_cvt_pk_bf16_f32 v144, v144, v145
  v_cvt_pk_bf16_f32 v145, v146, v147
  v_cvt_pk_bf16_f32 v146, v152, v153
  v_cvt_pk_bf16_f32 v147, v154, v155
  ds_write_b128 v198, v[144:147] offset:49152
  v_mul_f32 v148, v148, v10
  v_mul_f32 v149, v149, v10
  v_mul_f32 v150, v150, v10
  v_mul_f32 v151, v151, v10
  v_mul_f32 v156, v156, v10
  v_mul_f32 v157, v157, v10
  v_mul_f32 v158, v158, v10
  v_mul_f32 v159, v159, v10
  v_cvt_pk_bf16_f32 v148, v148, v149
  v_cvt_pk_bf16_f32 v149, v150, v151
  v_cvt_pk_bf16_f32 v150, v156, v157
  v_cvt_pk_bf16_f32 v151, v158, v159
  ds_write_b128 v198, v[148:151] offset:49664
  s_waitcnt lgkmcnt(0)
  s_barrier
  s_mov_b32 s50, 0xffff
  s_mov_b32 s51, 0x0
  s_mov_b32 s52, 0xffffffff
  s_mov_b32 s53, 0x0
  s_mov_b32 s54, 0xffffffff
  s_mov_b32 s55, 0xffff
  s_mov_b32 s64, 0xffff0000
  s_mov_b32 s65, 0xffffffff
  s_mov_b32 s66, 0x0
  s_mov_b32 s67, 0xffffffff
  s_mov_b32 s72, 0x0
  s_mov_b32 s73, 0xffff0000
  s_mov_b32 s44, 0xaaaaaaaa
  s_mov_b32 s45, 0xaaaaaaaa
  s_mov_b32 s46, 0xfff0ffff
  s_mov_b32 s47, 0xf000ff00
  s_mov_b32 s48, 0xffc0fffc
  s_mov_b32 s49, 0xc000fc00
  v_mov_b32 v13, 0x0000ffff
  v_mov_b32 v7, 0xffff0000
  v_cndmask_b32 v13, v13, v7, s[44:45]
  v_cndmask_b32 v1, v13, 0, s[46:47]
  v_cndmask_b32 v3, 0, v13, s[46:47]
  v_cndmask_b32 v2, v13, 0, s[48:49]
  v_cndmask_b32 v4, 0, v13, s[48:49]
  v_mov_b32 v8, s96
  v_mov_b32 v9, s96
  v_mov_b32 v10, s96
  v_mov_b32 v11, s96
  v_mov_b32 v12, 1.0
  v_and_b32 v6, 15, v0
  v_lshlrev_b32 v6, 4, v6
  v_bfe_u32 v7, v0, 4, 1
  v_lshl_add_u32 v6, v7, 9, v6
  v_lshrrev_b32 v7, 5, v0
  v_lshl_add_u32 v6, v7, 10, v6
  s_mov_b32 s12, 0x3e8b97f6
  ds_read_b128 v[108:111], v199 offset:32768
  ds_read_b128 v[112:115], v199 offset:34816
  ds_read_b128 v[152:155], v199 offset:33792
  ds_read_b128 v[156:159], v199 offset:35840
  s_waitcnt lgkmcnt(2)
  s_waitcnt lgkmcnt(0)
  v_mov_b32 v108, 0
  v_mov_b32 v152, 0
  v_mov_b32 v109, 0
  v_mov_b32 v153, 0
  v_cndmask_b32 v112, 0, v112, s[54:55]
  v_cndmask_b32 v156, 0, v156, s[54:55]
  v_cndmask_b32 v113, 0, v113, s[54:55]
  v_cndmask_b32 v157, 0, v157, s[54:55]
  v_mov_b32 v114, 0
  v_mov_b32 v158, 0
  v_mov_b32 v115, 0
  v_mov_b32 v159, 0
  ds_read_b128 v[116:119], v199 offset:34816
  ds_read_b128 v[120:123], v199 offset:49152
  ds_read_b128 v[160:163], v199 offset:35840
  ds_read_b128 v[164:167], v199 offset:50176
  s_waitcnt vmcnt(25)
  v_mfma_f32_16x16x32_bf16 v[124:127], a[32:35], v[108:111], v[8:11]
  s_waitcnt vmcnt(24)
  v_mfma_f32_16x16x32_bf16 v[168:171], a[36:39], v[152:155], 0
  v_mfma_f32_16x16x32_bf16 v[128:131], a[36:39], v[108:111], 0
  s_waitcnt vmcnt(23)
  v_mfma_f32_16x16x32_bf16 v[172:175], a[40:43], v[152:155], 0
  s_waitcnt vmcnt(20)
  v_mfma_f32_16x16x32_bf16 v[124:127], v[24:27], v[112:115], v[124:127]
  s_waitcnt vmcnt(19)
  v_mfma_f32_16x16x32_bf16 v[168:171], v[28:31], v[156:159], v[168:171]
  v_mfma_f32_16x16x32_bf16 v[128:131], v[28:31], v[112:115], v[128:131]
  s_waitcnt vmcnt(18)
  v_mfma_f32_16x16x32_bf16 v[172:175], v[32:35], v[156:159], v[172:175]
  s_nop 2
  v_cndmask_b32 v132, v124, v125, s[44:45]
  s_nop 0
  v_cndmask_b32 v176, v168, v169, s[44:45]
  v_cndmask_b32 v134, v128, v129, s[44:45]
  s_nop 0
  v_cndmask_b32 v178, v172, v173, s[44:45]
  v_cndmask_b32 v133, v126, v127, s[44:45]
  v_cndmask_b32 v177, v170, v171, s[44:45]
  v_cndmask_b32 v135, v130, v131, s[44:45]
  v_cndmask_b32 v179, v174, v175, s[44:45]
  v_cndmask_b32 v132, v132, v134, s[46:47]
  v_cndmask_b32 v176, v176, v178, s[46:47]
  v_cndmask_b32 v133, v133, v135, s[48:49]
  v_cndmask_b32 v177, v177, v179, s[48:49]
  v_max_f32 v134, v132, v133
  v_max_f32 v178, v176, v177
  v_mov_b32 v135, v134
  v_mov_b32 v179, v178
  s_nop 0
  v_permlane32_swap_b32 v134, v135
  v_permlane32_swap_b32 v178, v179
  v_max_f32 v134, v134, v135
  v_max_f32 v178, v178, v179
  v_mov_b32 v135, v134
  v_mov_b32 v179, v178
  s_nop 0
  v_permlane16_swap_b32 v134, v135
  v_permlane16_swap_b32 v178, v179
  v_max_f32 v134, v134, v135
  v_max_f32 v178, v178, v179
  v_sub_f32 v132, v132, v134
  v_sub_f32 v176, v176, v178
  v_sub_f32 v133, v133, v134
  v_sub_f32 v177, v177, v178
  v_mul_f32 v132, s12, v132
  v_mul_f32 v176, s12, v176
  v_mul_f32 v133, s12, v133
  v_mul_f32 v177, s12, v177
  v_exp_f32 v132, v132
  v_exp_f32 v176, v176
  v_exp_f32 v133, v133
  v_exp_f32 v177, v177
  v_add_f32 v134, v132, v133
  v_add_f32 v178, v176, v177
  s_nop 0
  v_mfma_f32_16x16x4_f32 v[124:127], v12, v134, 0
  v_mfma_f32_16x16x4_f32 v[168:171], v12, v178, 0
  s_nop 8
  v_rcp_f32 v135, v124
  v_rcp_f32 v179, v168
  v_mul_f32 v132, v132, v135
  v_mul_f32 v176, v176, v179
  v_mul_f32 v133, v133, v135
  v_mul_f32 v177, v177, v179
  v_cvt_pk_bf16_f32 v132, v132, v132
  v_cvt_pk_bf16_f32 v176, v176, v176
  v_cvt_pk_bf16_f32 v133, v133, v133
  v_cvt_pk_bf16_f32 v177, v177, v177
  v_and_b32 v128, v132, v1
  v_and_b32 v172, v176, v1
  v_and_b32 v129, v133, v2
  v_and_b32 v173, v177, v2
  v_and_b32 v130, v132, v3
  v_and_b32 v174, v176, v3
  v_and_b32 v131, v133, v4
  v_and_b32 v175, v177, v4
  s_nop 0
  v_mfma_f32_16x16x32_bf16 v[136:139], v[18:21], v[128:131], 0
  v_mfma_f32_16x16x32_bf16 v[180:183], v[20:23], v[172:175], 0
  s_waitcnt vmcnt(16)
  v_mfma_f32_16x16x32_bf16 v[144:147], v[38:41], v[128:131], 0
  v_mfma_f32_16x16x32_bf16 v[188:191], v[40:43], v[172:175], 0
  s_nop 3
  v_cvt_pk_bf16_f32 v202, v136, v137
  v_cvt_pk_bf16_f32 v206, v180, v181
  v_cvt_pk_bf16_f32 v203, v138, v139
  v_cvt_pk_bf16_f32 v207, v182, v183
  s_add_u32 s101, s59, 6144
  buffer_store_dwordx2 v[202:203], v6, s[60:63], s101 offen offset:8 sc1
  s_add_u32 s101, s59, 6144
  buffer_store_dwordx2 v[206:207], v6, s[60:63], s101 offen offset:264 sc1
  s_waitcnt lgkmcnt(2)
  s_waitcnt lgkmcnt(0)
  v_cndmask_b32 v116, 0, v116, s[72:73]
  v_cndmask_b32 v160, 0, v160, s[72:73]
  v_cndmask_b32 v117, 0, v117, s[72:73]
  v_cndmask_b32 v161, 0, v161, s[72:73]
  v_cndmask_b32 v120, 0, v120, s[52:53]
  v_cndmask_b32 v164, 0, v164, s[52:53]
  v_cndmask_b32 v121, 0, v121, s[52:53]
  v_cndmask_b32 v165, 0, v165, s[52:53]
  v_mov_b32 v122, 0
  v_mov_b32 v166, 0
  v_mov_b32 v123, 0
  v_mov_b32 v167, 0
  ds_read_b128 v[108:111], v199 offset:49152
  ds_read_b128 v[112:115], v199 offset:51200
  ds_read_b128 v[152:155], v199 offset:50176
  ds_read_b128 v[156:159], v199 offset:52224
  v_mfma_f32_16x16x32_bf16 v[124:127], v[24:27], v[116:119], v[8:11]
  v_mfma_f32_16x16x32_bf16 v[168:171], v[28:31], v[160:163], 0
  v_mfma_f32_16x16x32_bf16 v[128:131], v[28:31], v[116:119], 0
  v_mfma_f32_16x16x32_bf16 v[172:175], v[32:35], v[160:163], 0
  s_waitcnt vmcnt(15)
  v_mfma_f32_16x16x32_bf16 v[124:127], v[52:55], v[120:123], v[124:127]
  s_waitcnt vmcnt(14)
  v_mfma_f32_16x16x32_bf16 v[168:171], v[56:59], v[164:167], v[168:171]
  v_mfma_f32_16x16x32_bf16 v[128:131], v[56:59], v[120:123], v[128:131]
  s_waitcnt vmcnt(13)
  v_mfma_f32_16x16x32_bf16 v[172:175], v[60:63], v[164:167], v[172:175]
  s_nop 2
  v_cndmask_b32 v132, v124, v125, s[44:45]
  s_nop 0
  v_cndmask_b32 v176, v168, v169, s[44:45]
  v_cndmask_b32 v134, v128, v129, s[44:45]
  s_nop 0
  v_cndmask_b32 v178, v172, v173, s[44:45]
  v_cndmask_b32 v133, v126, v127, s[44:45]
  v_cndmask_b32 v177, v170, v171, s[44:45]
  v_cndmask_b32 v135, v130, v131, s[44:45]
  v_cndmask_b32 v179, v174, v175, s[44:45]
  v_cndmask_b32 v132, v132, v134, s[46:47]
  v_cndmask_b32 v176, v176, v178, s[46:47]
  v_cndmask_b32 v133, v133, v135, s[48:49]
  v_cndmask_b32 v177, v177, v179, s[48:49]
  v_max_f32 v134, v132, v133
  v_max_f32 v178, v176, v177
  v_mov_b32 v135, v134
  v_mov_b32 v179, v178
  s_nop 0
  v_permlane32_swap_b32 v134, v135
  v_permlane32_swap_b32 v178, v179
  v_max_f32 v134, v134, v135
  v_max_f32 v178, v178, v179
  v_mov_b32 v135, v134
  v_mov_b32 v179, v178
  s_nop 0
  v_permlane16_swap_b32 v134, v135
  v_permlane16_swap_b32 v178, v179
  v_max_f32 v134, v134, v135
  v_max_f32 v178, v178, v179
  v_sub_f32 v132, v132, v134
  v_sub_f32 v176, v176, v178
  v_sub_f32 v133, v133, v134
  v_sub_f32 v177, v177, v178
  v_mul_f32 v132, s12, v132
  v_mul_f32 v176, s12, v176
  v_mul_f32 v133, s12, v133
  v_mul_f32 v177, s12, v177
  v_exp_f32 v132, v132
  v_exp_f32 v176, v176
  v_exp_f32 v133, v133
  v_exp_f32 v177, v177
  v_add_f32 v134, v132, v133
  v_add_f32 v178, v176, v177
  s_nop 0
  v_mfma_f32_16x16x4_f32 v[124:127], v12, v134, 0
  v_mfma_f32_16x16x4_f32 v[168:171], v12, v178, 0
  s_nop 8
  v_rcp_f32 v135, v124
  v_rcp_f32 v179, v168
  v_mul_f32 v132, v132, v135
  v_mul_f32 v176, v176, v179
  v_mul_f32 v133, v133, v135
  v_mul_f32 v177, v177, v179
  v_cvt_pk_bf16_f32 v132, v132, v132
  v_cvt_pk_bf16_f32 v176, v176, v176
  v_cvt_pk_bf16_f32 v133, v133, v133
  v_cvt_pk_bf16_f32 v177, v177, v177
  v_and_b32 v128, v132, v1
  v_and_b32 v172, v176, v1
  v_and_b32 v129, v133, v2
  v_and_b32 v173, v177, v2
  v_and_b32 v130, v132, v3
  v_and_b32 v174, v176, v3
  v_and_b32 v131, v133, v4
  v_and_b32 v175, v177, v4
  s_nop 0
  v_mfma_f32_16x16x32_bf16 v[136:139], v[38:41], v[128:131], 0
  v_mfma_f32_16x16x32_bf16 v[180:183], v[40:43], v[172:175], 0
  v_mfma_f32_16x16x32_bf16 v[140:143], v[46:49], v[128:131], 0
  v_mfma_f32_16x16x32_bf16 v[184:187], v[48:51], v[172:175], 0
  s_waitcnt vmcnt(11)
  v_mfma_f32_16x16x32_bf16 v[148:151], v[66:69], v[128:131], 0
  v_mfma_f32_16x16x32_bf16 v[192:195], v[68:71], v[172:175], 0
  s_nop 1
  v_cndmask_b32 v136, v144, v136, s[72:73]
  v_cndmask_b32 v137, v145, v137, s[72:73]
  v_cndmask_b32 v138, v146, v138, s[72:73]
  v_cndmask_b32 v139, v147, v139, s[72:73]
  v_cndmask_b32 v180, v188, v180, s[72:73]
  v_cndmask_b32 v181, v189, v181, s[72:73]
  v_cndmask_b32 v182, v190, v182, s[72:73]
  v_cndmask_b32 v183, v191, v183, s[72:73]
  v_cvt_pk_bf16_f32 v200, v136, v137
  v_cvt_pk_bf16_f32 v204, v180, v181
  v_cvt_pk_bf16_f32 v201, v138, v139
  v_cvt_pk_bf16_f32 v205, v182, v183
  v_cvt_pk_bf16_f32 v202, v140, v141
  v_cvt_pk_bf16_f32 v206, v184, v185
  v_cvt_pk_bf16_f32 v203, v142, v143
  v_cvt_pk_bf16_f32 v207, v186, v187
  s_add_u32 s101, s59, 8192
  buffer_store_dwordx4 v[200:203], v6, s[60:63], s101 offen offset:0 sc1
  s_add_u32 s101, s59, 8192
  buffer_store_dwordx4 v[204:207], v6, s[60:63], s101 offen offset:256 sc1
  s_waitcnt lgkmcnt(2)
  s_waitcnt lgkmcnt(0)
  v_cndmask_b32 v108, 0, v108, s[66:67]
  v_cndmask_b32 v152, 0, v152, s[66:67]
  v_cndmask_b32 v109, 0, v109, s[66:67]
  v_cndmask_b32 v153, 0, v153, s[66:67]
  v_cndmask_b32 v112, 0, v112, s[50:51]
  v_cndmask_b32 v156, 0, v156, s[50:51]
  v_cndmask_b32 v113, 0, v113, s[50:51]
  v_cndmask_b32 v157, 0, v157, s[50:51]
  v_mov_b32 v114, 0
  v_mov_b32 v158, 0
  v_mov_b32 v115, 0
  v_mov_b32 v159, 0
  ds_read_b128 v[116:119], v199 offset:51200
  ds_read_b128 v[160:163], v199 offset:52224
  v_mfma_f32_16x16x32_bf16 v[124:127], v[52:55], v[108:111], v[8:11]
  v_mfma_f32_16x16x32_bf16 v[168:171], v[56:59], v[152:155], 0
  v_mfma_f32_16x16x32_bf16 v[128:131], v[56:59], v[108:111], 0
  v_mfma_f32_16x16x32_bf16 v[172:175], v[60:63], v[152:155], 0
  s_waitcnt vmcnt(10)
  v_mfma_f32_16x16x32_bf16 v[124:127], v[80:83], v[112:115], v[124:127]
  s_waitcnt vmcnt(9)
  v_mfma_f32_16x16x32_bf16 v[168:171], v[84:87], v[156:159], v[168:171]
  v_mfma_f32_16x16x32_bf16 v[128:131], v[84:87], v[112:115], v[128:131]
  s_waitcnt vmcnt(8)
  v_mfma_f32_16x16x32_bf16 v[172:175], v[88:91], v[156:159], v[172:175]
  s_nop 2
  v_cndmask_b32 v132, v124, v125, s[44:45]
  s_nop 0
  v_cndmask_b32 v176, v168, v169, s[44:45]
  v_cndmask_b32 v134, v128, v129, s[44:45]
  s_nop 0
  v_cndmask_b32 v178, v172, v173, s[44:45]
  v_cndmask_b32 v133, v126, v127, s[44:45]
  v_cndmask_b32 v177, v170, v171, s[44:45]
  v_cndmask_b32 v135, v130, v131, s[44:45]
  v_cndmask_b32 v179, v174, v175, s[44:45]
  v_cndmask_b32 v132, v132, v134, s[46:47]
  v_cndmask_b32 v176, v176, v178, s[46:47]
  v_cndmask_b32 v133, v133, v135, s[48:49]
  v_cndmask_b32 v177, v177, v179, s[48:49]
  v_max_f32 v134, v132, v133
  v_max_f32 v178, v176, v177
  v_mov_b32 v135, v134
  v_mov_b32 v179, v178
  s_nop 0
  v_permlane32_swap_b32 v134, v135
  v_permlane32_swap_b32 v178, v179
  v_max_f32 v134, v134, v135
  v_max_f32 v178, v178, v179
  v_mov_b32 v135, v134
  v_mov_b32 v179, v178
  s_nop 0
  v_permlane16_swap_b32 v134, v135
  v_permlane16_swap_b32 v178, v179
  v_max_f32 v134, v134, v135
  v_max_f32 v178, v178, v179
  v_sub_f32 v132, v132, v134
  v_sub_f32 v176, v176, v178
  v_sub_f32 v133, v133, v134
  v_sub_f32 v177, v177, v178
  v_mul_f32 v132, s12, v132
  v_mul_f32 v176, s12, v176
  v_mul_f32 v133, s12, v133
  v_mul_f32 v177, s12, v177
  v_exp_f32 v132, v132
  v_exp_f32 v176, v176
  v_exp_f32 v133, v133
  v_exp_f32 v177, v177
  v_add_f32 v134, v132, v133
  v_add_f32 v178, v176, v177
  s_nop 0
  v_mfma_f32_16x16x4_f32 v[124:127], v12, v134, 0
  v_mfma_f32_16x16x4_f32 v[168:171], v12, v178, 0
  s_nop 8
  v_rcp_f32 v135, v124
  v_rcp_f32 v179, v168
  v_mul_f32 v132, v132, v135
  v_mul_f32 v176, v176, v179
  v_mul_f32 v133, v133, v135
  v_mul_f32 v177, v177, v179
  v_cvt_pk_bf16_f32 v132, v132, v132
  v_cvt_pk_bf16_f32 v176, v176, v176
  v_cvt_pk_bf16_f32 v133, v133, v133
  v_cvt_pk_bf16_f32 v177, v177, v177
  v_and_b32 v128, v132, v1
  v_and_b32 v172, v176, v1
  v_and_b32 v129, v133, v2
  v_and_b32 v173, v177, v2
  v_and_b32 v130, v132, v3
  v_and_b32 v174, v176, v3
  v_and_b32 v131, v133, v4
  v_and_b32 v175, v177, v4
  s_nop 0
  v_mfma_f32_16x16x32_bf16 v[136:139], v[66:69], v[128:131], 0
  v_mfma_f32_16x16x32_bf16 v[180:183], v[68:71], v[172:175], 0
  v_mfma_f32_16x16x32_bf16 v[140:143], v[74:77], v[128:131], 0
  v_mfma_f32_16x16x32_bf16 v[184:187], v[76:79], v[172:175], 0
  s_waitcnt vmcnt(6)
  v_mfma_f32_16x16x32_bf16 v[144:147], v[94:97], v[128:131], 0
  v_mfma_f32_16x16x32_bf16 v[188:191], v[96:99], v[172:175], 0
  s_nop 1
  v_cndmask_b32 v136, v148, v136, s[66:67]
  v_cndmask_b32 v137, v149, v137, s[66:67]
  v_cndmask_b32 v138, v150, v138, s[66:67]
  v_cndmask_b32 v139, v151, v139, s[66:67]
  v_cndmask_b32 v180, v192, v180, s[66:67]
  v_cndmask_b32 v181, v193, v181, s[66:67]
  v_cndmask_b32 v182, v194, v182, s[66:67]
  v_cndmask_b32 v183, v195, v183, s[66:67]
  v_cvt_pk_bf16_f32 v200, v136, v137
  v_cvt_pk_bf16_f32 v204, v180, v181
  v_cvt_pk_bf16_f32 v201, v138, v139
  v_cvt_pk_bf16_f32 v205, v182, v183
  v_cvt_pk_bf16_f32 v202, v140, v141
  v_cvt_pk_bf16_f32 v206, v184, v185
  v_cvt_pk_bf16_f32 v203, v142, v143
  v_cvt_pk_bf16_f32 v207, v186, v187
  s_add_u32 s101, s59, 10240
  buffer_store_dwordx4 v[200:203], v6, s[60:63], s101 offen offset:0 sc1
  s_add_u32 s101, s59, 10240
  buffer_store_dwordx4 v[204:207], v6, s[60:63], s101 offen offset:256 sc1
  s_waitcnt lgkmcnt(1)
  s_waitcnt lgkmcnt(0)
  v_cndmask_b32 v116, 0, v116, s[64:65]
  v_cndmask_b32 v160, 0, v160, s[64:65]
  v_cndmask_b32 v117, 0, v117, s[64:65]
  v_cndmask_b32 v161, 0, v161, s[64:65]
  s_nop 0
  v_mfma_f32_16x16x32_bf16 v[124:127], v[80:83], v[116:119], v[8:11]
  v_mfma_f32_16x16x32_bf16 v[168:171], v[84:87], v[160:163], 0
  v_mfma_f32_16x16x32_bf16 v[128:131], v[84:87], v[116:119], 0
  v_mfma_f32_16x16x32_bf16 v[172:175], v[88:91], v[160:163], 0
  s_nop 4
  v_cndmask_b32 v132, v124, v125, s[44:45]
  v_cndmask_b32 v176, v168, v169, s[44:45]
  v_cndmask_b32 v134, v128, v129, s[44:45]
  v_cndmask_b32 v178, v172, v173, s[44:45]
  v_cndmask_b32 v133, v126, v127, s[44:45]
  v_cndmask_b32 v177, v170, v171, s[44:45]
  v_cndmask_b32 v135, v130, v131, s[44:45]
  v_cndmask_b32 v179, v174, v175, s[44:45]
  v_cndmask_b32 v132, v132, v134, s[46:47]
  v_cndmask_b32 v176, v176, v178, s[46:47]
  v_cndmask_b32 v133, v133, v135, s[48:49]
  v_cndmask_b32 v177, v177, v179, s[48:49]
  v_max_f32 v134, v132, v133
  v_max_f32 v178, v176, v177
  v_mov_b32 v135, v134
  v_mov_b32 v179, v178
  s_nop 0
  v_permlane32_swap_b32 v134, v135
  v_permlane32_swap_b32 v178, v179
  v_max_f32 v134, v134, v135
  v_max_f32 v178, v178, v179
  v_mov_b32 v135, v134
  v_mov_b32 v179, v178
  s_nop 0
  v_permlane16_swap_b32 v134, v135
  v_permlane16_swap_b32 v178, v179
  v_max_f32 v134, v134, v135
  v_max_f32 v178, v178, v179
  v_sub_f32 v132, v132, v134
  v_sub_f32 v176, v176, v178
  v_sub_f32 v133, v133, v134
  v_sub_f32 v177, v177, v178
  v_mul_f32 v132, s12, v132
  v_mul_f32 v176, s12, v176
  v_mul_f32 v133, s12, v133
  v_mul_f32 v177, s12, v177
  v_exp_f32 v132, v132
  v_exp_f32 v176, v176
  v_exp_f32 v133, v133
  v_exp_f32 v177, v177
  v_add_f32 v134, v132, v133
  v_add_f32 v178, v176, v177
  s_nop 0
  v_mfma_f32_16x16x4_f32 v[124:127], v12, v134, 0
  v_mfma_f32_16x16x4_f32 v[168:171], v12, v178, 0
  s_nop 8
  v_rcp_f32 v135, v124
  v_rcp_f32 v179, v168
  v_mul_f32 v132, v132, v135
  v_mul_f32 v176, v176, v179
  v_mul_f32 v133, v133, v135
  v_mul_f32 v177, v177, v179
  v_cvt_pk_bf16_f32 v132, v132, v132
  v_cvt_pk_bf16_f32 v176, v176, v176
  v_cvt_pk_bf16_f32 v133, v133, v133
  v_cvt_pk_bf16_f32 v177, v177, v177
  v_and_b32 v128, v132, v1
  v_and_b32 v172, v176, v1
  v_and_b32 v129, v133, v2
  v_and_b32 v173, v177, v2
  v_and_b32 v130, v132, v3
  v_and_b32 v174, v176, v3
  v_and_b32 v131, v133, v4
  v_and_b32 v175, v177, v4
  s_nop 0
  v_mfma_f32_16x16x32_bf16 v[136:139], v[94:97], v[128:131], 0
  v_mfma_f32_16x16x32_bf16 v[180:183], v[96:99], v[172:175], 0
  s_waitcnt vmcnt(6)
  v_mfma_f32_16x16x32_bf16 v[148:151], v[102:105], v[128:131], 0
  v_mfma_f32_16x16x32_bf16 v[192:195], v[104:107], v[172:175], 0
  s_nop 3
  v_cndmask_b32 v136, v144, v136, s[64:65]
  v_cndmask_b32 v137, v145, v137, s[64:65]
  v_cndmask_b32 v138, v146, v138, s[64:65]
  v_cndmask_b32 v139, v147, v139, s[64:65]
  v_cndmask_b32 v180, v188, v180, s[64:65]
  v_cndmask_b32 v181, v189, v181, s[64:65]
  v_cndmask_b32 v182, v190, v182, s[64:65]
  v_cndmask_b32 v183, v191, v183, s[64:65]
  v_cvt_pk_bf16_f32 v200, v136, v137
  v_cvt_pk_bf16_f32 v204, v180, v181
  v_cvt_pk_bf16_f32 v201, v138, v139
  v_cvt_pk_bf16_f32 v205, v182, v183
  v_cvt_pk_bf16_f32 v202, v148, v149
  v_cvt_pk_bf16_f32 v206, v192, v193
  v_cvt_pk_bf16_f32 v203, v150, v151
  v_cvt_pk_bf16_f32 v207, v194, v195
  s_add_u32 s101, s59, 12288
  buffer_store_dwordx4 v[200:203], v6, s[60:63], s101 offen offset:0 sc1
  s_add_u32 s101, s59, 12288
  buffer_store_dwordx4 v[204:207], v6, s[60:63], s101 offen offset:256 sc1
  s_waitcnt vmcnt(0)
  s_mov_b64 exec, 1
  buffer_store_dwordx2 v[14:15], off, s[60:63], s14 offset:3072 sc1
  s_mov_b64 exec, -1
  s_endpgm
SLOW3:
  s_mov_b32 s15, 200000
SLOWL3:
  buffer_load_dwordx2 v[14:15], v203, s[68:71], 0 offen offset:0 sc1
  s_waitcnt vmcnt(0)
  v_cmp_eq_u64 vcc, 0, v[14:15]
  s_cbranch_vccz BACK3
  s_sub_u32 s15, s15, 1
  s_cbranch_scc0 SLOWL3
  s_branch BACK3
SLOW4:
  s_mov_b32 s15, 200000
SLOWL4:
  buffer_load_dwordx2 v[6:7], v13, s[60:63], s10 offen offset:1024 sc1
  s_waitcnt vmcnt(0)
  v_cmp_ne_u64 vcc, v[6:7], v[14:15]
  s_cbranch_vccz BACK4
  s_sub_u32 s15, s15, 1
  s_cbranch_scc0 SLOWL4
  s_branch BACK4
SLOW5:
  s_mov_b32 s15, 200000
SLOWL5:
  buffer_load_dwordx2 v[6:7], v13, s[60:63], s10 offen offset:2048 sc1
  s_waitcnt vmcnt(0)
  v_cmp_ne_u64 vcc, v[6:7], v[14:15]
  s_cbranch_vccz BACK5
  s_sub_u32 s15, s15, 1
  s_cbranch_scc0 SLOWL5
  s_branch BACK5
SLOW6:
  s_mov_b32 s15, 200000
SLOWL6:
  buffer_load_dwordx2 v[6:7], v13, s[60:63], s10 offen offset:3072 sc1
  s_waitcnt vmcnt(0)
  v_cmp_ne_u64 vcc, v[6:7], v[14:15]
  s_cbranch_vccz BACK6
  s_sub_u32 s15, s15, 1
  s_cbranch_scc0 SLOWL6
  s_branch BACK6
SLOW8:
  s_mov_b32 s15, 200000
SLOWL8:
  buffer_load_dwordx2 v[14:15], v203, s[68:71], 0 offen offset:0 sc1
  s_waitcnt vmcnt(0)
  v_cmp_eq_u64 vcc, 0, v[14:15]
  s_cbranch_vccz BACK8
  s_sub_u32 s15, s15, 1
  s_cbranch_scc0 SLOWL8
  s_branch BACK8
SLOW9:
  s_mov_b32 s15, 200000
SLOWL9:
  buffer_load_dwordx2 v[196:197], v13, s[60:63], s12 offen offset:0 sc1
  s_waitcnt vmcnt(0)
  v_cmp_ne_u64 vcc, v[196:197], v[14:15]
  s_cbranch_vccz BACK9
  s_sub_u32 s15, s15, 1
  s_cbranch_scc0 SLOWL9
  s_branch BACK9
SLOW10:
  s_mov_b32 s15, 200000
SLOWL10:
  buffer_load_dwordx2 v[196:197], v13, s[60:63], s12 offen offset:0 sc1
  s_waitcnt vmcnt(0)
  v_cmp_ne_u64 vcc, v[196:197], v[14:15]
  s_cbranch_vccz BACK10
  s_sub_u32 s15, s15, 1
  s_cbranch_scc0 SLOWL10
  s_branch BACK10
END:
  s_endpgm
.fill 8192, 4, 0xbf810000
.section .rodata,"a"
.p2align 6
.amdhsa_kernel recurrent_scan__sliding_local_dilated__swiglu_ffn__prompt_kernel
  .amdhsa_next_free_vgpr 256
  .amdhsa_next_free_sgpr 102
  .amdhsa_accum_offset 208
  .amdhsa_group_segment_fixed_size 0
  .amdhsa_kernarg_size 80
  .amdhsa_user_sgpr_count 2
  .amdhsa_user_sgpr_kernarg_segment_ptr 1
  .amdhsa_system_sgpr_workgroup_id_x 1
.end_amdhsa_kernel
```
